```python
import torch

def _softmax(x, axis=-1):
    return torch.softmax(x, dim=axis)
def _gelu(x):
    return torch.nn.functional.gelu(x, approximate="tanh")
def _silu(x):
    return torch.nn.functional.silu(x)
def _sigmoid(x):
    return torch.sigmoid(x)
def _layernorm(x, axis=-1, eps=1e-5):
    m = x.mean(dim=axis, keepdim=True)
    v = x.var(dim=axis, keepdim=True, unbiased=False)
    return (x - m) / torch.sqrt(v + eps)
def _scatter_add(tgt, idx, src, axis=0):
    return tgt.clone().index_add_(axis, idx, src)
def _segment_sum(src, seg, n):
    out = torch.zeros((n,) + src.shape[1:], dtype=src.dtype)
    return out.index_add_(0, seg, src)
def _pad(x, pw):
    flat = tuple(v for pair in reversed(pw) for v in pair)
    return torch.nn.functional.pad(x, flat)

kernel_name = 'gather_scatter__hybrid_graph_tf_graphgps__graph'

def setup_inputs():

    _w = (lambda a: (lambda t: t.to(torch.bfloat16) if t.is_floating_point() else t)(torch.as_tensor(a)))
    N, deg, D = 10000, 64, 64
    E = N * deg
    src = (lambda lo, hi, *s: torch.randint(lo, hi, s))(0, N, E).to(torch.int64)
    dst = (lambda lo, hi, *s: torch.randint(lo, hi, s))(0, N, E).to(torch.int64)
    deg_cnt = torch.bincount(dst, minlength=N).to(float) + 1.0
    sc = 1.0 / float(D) ** 0.5
    return {
        "x": _w((lambda *s: torch.randn(*s, dtype=torch.bfloat16) * 0.05)(N, D)),
        "src": _w(src),
        "dst": _w(dst),
        "deg_inv": _w((1.0 / deg_cnt).to(float)),
        "w_msg": _w((lambda *s: torch.randn(*s, dtype=torch.bfloat16) * 0.4)(D, D) * sc),
        "wq": _w((lambda *s: torch.randn(*s, dtype=torch.bfloat16) * 1.6)(D, D) * sc),
        "wk": _w((lambda *s: torch.randn(*s, dtype=torch.bfloat16) * 1.6)(D, D) * sc),
        "wv": _w((lambda *s: torch.randn(*s, dtype=torch.bfloat16) * 0.2)(D, D) * sc),
        "w_out": _w((lambda *s: torch.randn(*s, dtype=torch.bfloat16) * 0.2)(D, D) * sc),
    }

def reference(x, src, dst, deg_inv, w_msg, wq, wk, wv, w_out):
    N, D = x.shape[0], x.shape[1]
    h = _layernorm(x, axis=-1)
    m_e = torch.einsum('nd,de->ne', h, w_msg)
    h_local = _segment_sum(m_e[src], dst, N) * deg_inv[:, None]
    q = torch.einsum('nd,de->ne', h, wq)
    k = torch.einsum('nd,de->ne', h, wk)
    v = torch.einsum('nd,de->ne', h, wv)
    logits = torch.einsum('id,jd->ij', q, k) / (float(D) ** 0.5)
    attn = _softmax(logits, axis=-1)
    h_global = torch.einsum('ij,jd->id', attn, v)
    y = torch.einsum('nd,de->ne', h_local + h_global, w_out)
    return x + y
```

```asm
; @launch grid=(253,1,1) block=(768,1,1) lds=163840
.amdgcn_target "amdgcn-amd-amdhsa--gfx950"
.text
.globl gather_scatter__hybrid_graph_tf_graphgps__graph_kernel
.p2align 8
.type gather_scatter__hybrid_graph_tf_graphgps__graph_kernel,@function
gather_scatter__hybrid_graph_tf_graphgps__graph_kernel:
    s_load_dwordx16 s[36:51], s[0:1], 0
    s_load_dwordx8 s[52:59], s[0:1], 64
    v_lshrrev_b32 v1, 6, v0
    v_and_b32 v9, 63, v0
    s_sub_u32 s2, s2, 1
    v_readfirstlane_b32 s6, v1
    s_cbranch_scc1 KF_AUX
    s_cmp_ge_u32 s2, 252
    s_cbranch_scc1 KF_END
    v_lshlrev_b32 v11, 4, v0
    v_lshlrev_b32 v10, 4, v9
    v_mov_b64 v[124:125], -1
    v_mov_b64 v[126:127], -1
    v_add_u32 v128, 149504, v11
    v_mul_u32_u24 v129, 356, v0
    v_add_u32 v129, 149600, v129
    v_cmp_gt_u32 vcc, 256, v0
    v_lshlrev_b32 v130, 2, v0
    v_add_u32 v130, 131072, v130
    v_cndmask_b32 v129, 0, v129, vcc
    ds_write_b128 v128, v[124:127]
    ds_write_b128 v128, v[124:127] offset:2048
    ds_write_b32 v130, v129
    s_lshr_b32 s7, s2, 2
    s_and_b32 s8, s2, 3
    s_mul_i32 s19, s7, 20480
    s_mul_i32 s12, s8, 5
    s_lshl_b32 s16, s6, 1
    s_sub_u32 s17, s16, 5
    s_sub_u32 s16, s16, 4
    s_cmp_lt_u32 s6, 5
    s_cselect_b32 s16, s6, s16
    s_add_u32 s13, s17, 5
    s_cmp_lt_u32 s17, s12
    s_cselect_b32 s17, s17, s13
    s_add_u32 s13, s16, 5
    s_cmp_lt_u32 s16, s12
    s_cselect_b32 s16, s16, s13
    s_add_u32 s13, s12, s6
    s_cmp_lt_u32 s6, 5
    s_cselect_b32 s17, s13, s17
    s_lshl_b32 s12, s17, 10
    s_add_u32 s12, s12, s19
    s_lshl_b32 s13, s16, 10
    s_add_u32 s13, s13, s19
    v_add_u32 v58, s12, v10
    v_add_u32 v59, s13, v10
    s_mul_i32 s24, s2, 10240
    s_cmp_ge_u32 s2, 250
    s_cselect_b32 s24, 0, s24
    s_and_b32 s22, s6, 3
    s_mul_i32 s22, s22, 2560
    s_add_u32 s22, s22, s24
    v_add_u32 v152, s22, v10
    v_lshlrev_b32 v153, 3, v9
    v_add_u32 v153, s22, v153
    s_mov_b32 s62, 0x138800
    s_mov_b32 s63, 0x20000
    v_lshrrev_b32 v22, 2, v9
    v_and_b32 v23, 3, v9
    s_mul_i32 s11, s8, 80
    s_add_u32 s11, s11, s6
    s_lshl_b32 s11, s11, 12
    v_lshlrev_b32 v22, 7, v22
    v_lshl_add_u32 v22, v23, 4, v22
    v_add_u32 v22, s11, v22
    s_cmp_ge_u32 s6, 10
    s_cbranch_scc1 KF_MLD
    s_waitcnt lgkmcnt(0)
    s_mov_b32 s60, s36
    s_mov_b32 s61, s37
    buffer_load_dwordx4 v[12:15], v58, s[60:63], 0 offen
    buffer_load_dwordx4 v[16:19], v59, s[60:63], 0 offen
    s_cmp_ge_u32 s6, 8
KF_INIT:
    s_barrier
    s_mov_b32 s4, s58
    s_mov_b32 s5, s59
    s_mov_b32 s80, s56
    s_mov_b32 s81, s57
    s_cbranch_scc1 KF_NX
    global_load_dwordx4 v[88:91], v22, s[36:37] offset:0
    global_load_dwordx4 v[92:95], v22, s[36:37] offset:64
    global_load_dwordx4 v[96:99], v22, s[36:37] offset:2048
    global_load_dwordx4 v[64:67], v22, s[36:37] offset:2112
KF_NX:
    s_mov_b32 s3, 0xffff0000
    v_lshrrev_b32 v1, 3, v9
    v_and_b32 v2, 7, v9
    v_and_b32 v3, 3, v9
    v_lshlrev_b32 v3, 2, v3
    v_xor_b32 v3, v3, v1
    v_lshlrev_b32 v3, 4, v3
    v_lshl_add_u32 v3, v2, 9, v3
    s_and_b32 s22, s17, 3
    s_lshl_b32 s22, s22, 7
    s_lshr_b32 s23, s17, 2
    s_lshl_b32 s23, s23, 12
    s_or_b32 s22, s22, s23
    v_xor_b32 v56, s22, v3
    s_and_b32 s22, s16, 3
    s_lshl_b32 s22, s22, 7
    s_lshr_b32 s23, s16, 2
    s_lshl_b32 s23, s23, 12
    s_or_b32 s22, s22, s23
    v_xor_b32 v63, s22, v3
    v_add_u32 v62, 106496, v56
    v_add_u32 v63, 106496, v63
    s_cmp_lt_u32 s12, s62
    s_cselect_b32 s68, 0x80808080, 0
    s_mov_b32 s69, s68
    s_cmp_lt_u32 s13, s62
    s_cselect_b32 s70, 0x80808080, 0
    s_mov_b32 s71, s70
    s_add_u32 s72, s4, s19
    s_addc_u32 s73, s5, 0
    s_cmp_ge_u32 s6, 8
    s_cbranch_scc1 KF_L8
    s_lshl_b32 s16, s2, 7
    s_add_u32 s16, s16, 0x700000
    v_mov_b32 v60, s16
    s_add_u32 s64, s4, 0x280000
    s_addc_u32 s65, s5, 0
    s_mov_b32 s66, 0x138800
    s_mov_b32 s67, 0x20000
    s_and_b32 s9, s6, 3
    s_lshr_b32 s14, s6, 2
    v_and_b32 v1, 31, v9
    s_mul_i32 s18, s9, 40
    v_add_u32 v2, s18, v1
    v_lshrrev_b32 v3, 3, v1
    v_lshl_add_u32 v3, v3, 5, v1
    v_add_u32 v3, 32, v3
    s_add_u32 s18, s9, 1
    s_and_b32 s18, s18, 3
    s_mul_i32 s18, s18, 40
    v_add_u32 v4, s18, v1
    s_cmp_eq_u32 s14, 0
    s_cselect_b64 vcc, -1, 0
    v_cndmask_b32 v3, v3, v4, vcc
    v_lshrrev_b32 v1, 5, v9
    v_lshlrev_b32 v4, 2, v1
    v_xor_b32 v4, v4, v2
    v_and_b32 v5, 31, v4
    v_lshrrev_b32 v4, 5, v4
    v_lshlrev_b32 v4, 12, v4
    v_lshl_add_u32 v4, v5, 4, v4
    v_lshl_add_u32 v4, v1, 9, v4
    v_add_u32 v69, 106496, v4
    v_xor_b32 v70, 128, v69
    v_lshlrev_b32 v4, 2, v1
    v_xor_b32 v4, v4, v3
    v_and_b32 v5, 31, v4
    v_lshrrev_b32 v4, 5, v4
    v_lshlrev_b32 v4, 12, v4
    v_lshl_add_u32 v4, v5, 4, v4
    v_lshl_add_u32 v4, v1, 9, v4
    v_add_u32 v57, 106496, v4
    v_xor_b32 v61, 128, v57
    v_add_u32 v68, 98304, v10
    v_mov_b32 v8, 4
    v_and_b32 v1, 31, v9
    v_lshrrev_b32 v2, 5, v9
    v_lshlrev_b32 v20, 2, v2
    v_xor_b32 v20, v20, v1
    v_lshlrev_b32 v20, 4, v20
    v_lshl_add_u32 v20, v2, 9, v20
    v_bfe_u32 v1, v9, 4, 1
    v_bfe_u32 v21, v9, 1, 1
    v_lshl_or_b32 v1, v1, 1, v21
    v_bfe_u32 v21, v9, 2, 2
    v_lshl_or_b32 v21, v2, 2, v21
    v_lshlrev_b32 v3, 2, v1
    v_xor_b32 v21, v21, v3
    v_lshlrev_b32 v21, 4, v21
    v_lshl_add_u32 v21, v1, 9, v21
    v_and_b32 v3, 1, v9
    v_lshl_add_u32 v21, v3, 3, v21
    s_lshl_b32 s18, s14, 12
    s_xor_b32 s19, s14, 1
    s_mul_i32 s19, s19, 5
    s_lshl1_add_u32 s19, s9, s19
    s_and_b32 s19, s19, 7
    s_lshl_b32 s19, s19, 12
    s_cmp_ge_u32 s19, 24576
    s_cselect_b32 s21, 0, s19
    v_add_u32 v0, s21, v20
    v_add_u32 v2, s21, v21
    v_xor_b32 v1, 128, v0
    v_xor_b32 v3, 128, v2
    v_add_u32 v4, s19, v20
    v_xor_b32 v5, 128, v4
    s_lshl_b32 s17, s6, 5
    s_add_u32 s17, s17, 132096
    v_and_b32 v20, 3, v9
    v_lshl_add_u32 v6, v20, 2, s17
    v_mov_b32 v7, 1
    s_mov_b32 s20, 5
    v_lshrrev_b32 v71, 2, v9
    v_lshlrev_b32 v21, 2, v20
    v_xor_b32 v71, v71, v21
    v_lshlrev_b32 v71, 4, v71
    v_lshl_add_u32 v71, v20, 9, v71
    s_lshl_b32 s17, s6, 12
    v_add_u32 v71, s17, v71
    s_mov_b32 s74, 0x88888888
    s_mov_b32 s75, s74
    s_mul_i32 s25, s2, 20480
    s_add_u32 s25, s25, 0x900000
    s_lshl_b32 s26, s9, 12
    s_add_u32 s26, s26, s25
    s_add_u32 s28, s4, s26
    s_addc_u32 s29, s5, 0
    s_lshl_b32 s26, s9, 10
    s_add_u32 s25, s25, s26
    s_add_u32 s25, s25, 16384
    s_add_u32 s30, s4, s25
    s_addc_u32 s31, s5, 0
    v_mov_b64 v[104:105], 0
    v_mov_b64 v[106:107], 0
    v_mov_b64 v[108:109], 0
    v_mov_b64 v[110:111], 0
    v_mov_b64 v[112:113], 0
    v_mov_b64 v[114:115], 0
    v_mov_b64 v[116:117], 0
    v_mov_b64 v[118:119], 0
    v_mov_b64 v[120:121], 0
    v_mov_b64 v[122:123], 0
    v_mov_b64 v[124:125], 0
    v_mov_b64 v[126:127], 0
    v_mov_b64 v[128:129], 0
    v_mov_b64 v[130:131], 0
    v_mov_b64 v[132:133], 0
    v_mov_b64 v[134:135], 0
    v_mov_b64 v[136:137], 0
    v_mov_b64 v[138:139], 0
    v_mov_b64 v[140:141], 0
    v_mov_b64 v[142:143], 0
    v_mov_b64 v[144:145], 0
    v_mov_b64 v[146:147], 0
    v_mov_b64 v[148:149], 0
    v_mov_b64 v[150:151], 0
    v_mov_b64 v[152:153], 0
    v_mov_b64 v[154:155], 0
    v_mov_b64 v[156:157], 0
    v_mov_b64 v[158:159], 0
    v_mov_b64 v[160:161], 0
    v_mov_b64 v[162:163], 0
    v_mov_b64 v[164:165], 0
    v_mov_b64 v[166:167], 0
    s_cmp_lt_u32 s6, 5
    s_cbranch_scc0 KF_LW
    s_setprio 3
KF_LW:
    s_waitcnt vmcnt(5)
    v_lshlrev_b32 v20, 16, v12
    v_and_b32 v21, s3, v12
    v_lshlrev_b32 v22, 16, v13
    v_and_b32 v23, s3, v13
    v_lshlrev_b32 v24, 16, v14
    v_and_b32 v25, s3, v14
    v_lshlrev_b32 v26, 16, v15
    v_and_b32 v27, s3, v15
    v_pk_add_f32 v[36:37], v[20:21], v[22:23]
    v_pk_add_f32 v[38:39], v[24:25], v[26:27]
    v_pk_add_f32 v[36:37], v[36:37], v[38:39]
    v_add_f32 v36, v36, v37
    s_nop 1
    v_add_f32_dpp v36, v36, v36 quad_perm:[1,0,3,2] row_mask:0xf bank_mask:0xf
    s_nop 1
    v_add_f32_dpp v36, v36, v36 quad_perm:[2,3,0,1] row_mask:0xf bank_mask:0xf
    s_nop 1
    v_add_f32_dpp v36, v36, v36 row_half_mirror row_mask:0xf bank_mask:0xf
    v_mul_f32 v36, 0xbc800000, v36
    v_pk_add_f32 v[20:21], v[20:21], v[36:37] op_sel_hi:[1,0]
    v_pk_add_f32 v[22:23], v[22:23], v[36:37] op_sel_hi:[1,0]
    v_pk_add_f32 v[24:25], v[24:25], v[36:37] op_sel_hi:[1,0]
    v_pk_add_f32 v[26:27], v[26:27], v[36:37] op_sel_hi:[1,0]
    v_pk_mul_f32 v[38:39], v[20:21], v[20:21]
    v_pk_mul_f32 v[40:41], v[22:23], v[22:23]
    v_pk_fma_f32 v[38:39], v[24:25], v[24:25], v[38:39]
    v_pk_fma_f32 v[40:41], v[26:27], v[26:27], v[40:41]
    v_pk_add_f32 v[38:39], v[38:39], v[40:41]
    v_add_f32 v36, v38, v39
    s_nop 1
    v_add_f32_dpp v36, v36, v36 quad_perm:[1,0,3,2] row_mask:0xf bank_mask:0xf
    s_nop 1
    v_add_f32_dpp v36, v36, v36 quad_perm:[2,3,0,1] row_mask:0xf bank_mask:0xf
    s_nop 1
    v_add_f32_dpp v36, v36, v36 row_half_mirror row_mask:0xf bank_mask:0xf
    v_mov_b32 v38, 0x3727c5ac
    v_fmac_f32 v38, 0x3c800000, v36
    v_rsq_f32 v36, v38
    s_nop 0
    v_pk_mul_f32 v[20:21], v[20:21], v[36:37] op_sel_hi:[1,0]
    v_pk_mul_f32 v[22:23], v[22:23], v[36:37] op_sel_hi:[1,0]
    v_pk_mul_f32 v[24:25], v[24:25], v[36:37] op_sel_hi:[1,0]
    v_pk_mul_f32 v[26:27], v[26:27], v[36:37] op_sel_hi:[1,0]
    v_cndmask_b32 v38, v27, 1.0, s[68:69]
    v_cvt_pk_bf16_f32 v48, v20, v21
    v_cvt_pk_bf16_f32 v49, v22, v23
    v_cvt_pk_bf16_f32 v50, v24, v25
    v_cvt_pk_bf16_f32 v51, v26, v38
    s_cbranch_scc0 KF_NP
    global_store_dwordx4 v56, v[48:51], s[72:73] sc1
    s_setprio 0
    v_cvt_pk_f16_f32 v52, v20, v21
    v_cvt_pk_f16_f32 v53, v22, v23
    v_cvt_pk_f16_f32 v54, v24, v25
    v_cvt_pk_f16_f32 v55, v26, v27
    s_waitcnt vmcnt(5)
    s_branch KF_NP1
KF_NP:
    s_waitcnt vmcnt(4)
KF_NP1:
    ds_write_b128 v62, v[48:51]
    v_lshlrev_b32 v28, 16, v16
    v_and_b32 v29, s3, v16
    v_lshlrev_b32 v30, 16, v17
    v_and_b32 v31, s3, v17
    v_lshlrev_b32 v32, 16, v18
    v_and_b32 v33, s3, v18
    v_lshlrev_b32 v34, 16, v19
    v_and_b32 v35, s3, v19
    v_pk_add_f32 v[42:43], v[28:29], v[30:31]
    v_pk_add_f32 v[44:45], v[32:33], v[34:35]
    v_pk_add_f32 v[42:43], v[42:43], v[44:45]
    v_add_f32 v42, v42, v43
    s_nop 1
    v_add_f32_dpp v42, v42, v42 quad_perm:[1,0,3,2] row_mask:0xf bank_mask:0xf
    s_nop 1
    v_add_f32_dpp v42, v42, v42 quad_perm:[2,3,0,1] row_mask:0xf bank_mask:0xf
    s_nop 1
    v_add_f32_dpp v42, v42, v42 row_half_mirror row_mask:0xf bank_mask:0xf
    v_mul_f32 v42, 0xbc800000, v42
    v_pk_add_f32 v[28:29], v[28:29], v[42:43] op_sel_hi:[1,0]
    v_pk_add_f32 v[30:31], v[30:31], v[42:43] op_sel_hi:[1,0]
    v_pk_add_f32 v[32:33], v[32:33], v[42:43] op_sel_hi:[1,0]
    v_pk_add_f32 v[34:35], v[34:35], v[42:43] op_sel_hi:[1,0]
    v_pk_mul_f32 v[44:45], v[28:29], v[28:29]
    v_pk_mul_f32 v[46:47], v[30:31], v[30:31]
    v_pk_fma_f32 v[44:45], v[32:33], v[32:33], v[44:45]
    v_pk_fma_f32 v[46:47], v[34:35], v[34:35], v[46:47]
    v_pk_add_f32 v[44:45], v[44:45], v[46:47]
    v_add_f32 v42, v44, v45
    s_nop 1
    v_add_f32_dpp v42, v42, v42 quad_perm:[1,0,3,2] row_mask:0xf bank_mask:0xf
    s_nop 1
    v_add_f32_dpp v42, v42, v42 quad_perm:[2,3,0,1] row_mask:0xf bank_mask:0xf
    s_nop 1
    v_add_f32_dpp v42, v42, v42 row_half_mirror row_mask:0xf bank_mask:0xf
    v_mov_b32 v44, 0x3727c5ac
    v_fmac_f32 v44, 0x3c800000, v42
    v_rsq_f32 v42, v44
    s_nop 0
    v_pk_mul_f32 v[28:29], v[28:29], v[42:43] op_sel_hi:[1,0]
    v_pk_mul_f32 v[30:31], v[30:31], v[42:43] op_sel_hi:[1,0]
    v_pk_mul_f32 v[32:33], v[32:33], v[42:43] op_sel_hi:[1,0]
    v_pk_mul_f32 v[34:35], v[34:35], v[42:43] op_sel_hi:[1,0]
    v_cndmask_b32 v44, v35, 1.0, s[70:71]
    v_cvt_pk_bf16_f32 v12, v28, v29
    v_cvt_pk_bf16_f32 v13, v30, v31
    v_cvt_pk_bf16_f32 v14, v32, v33
    v_cvt_pk_bf16_f32 v15, v34, v44
    ds_write_b128 v63, v[12:15]
    s_cmp_eq_u32 s2, 251
    s_cbranch_scc1 KF_PAD
KF_SG:
    s_cmp_lt_u32 s6, 5
    s_waitcnt vmcnt(1)
    s_cbranch_scc1 KF_X1
    s_waitcnt vmcnt(0)
KF_X1:
    v_lshlrev_b32 v20, 16, v88
    v_lshlrev_b32 v36, 16, v96
    v_and_b32 v21, s3, v88
    v_and_b32 v37, s3, v96
    v_lshlrev_b32 v22, 16, v89
    v_lshlrev_b32 v38, 16, v97
    v_and_b32 v23, s3, v89
    v_and_b32 v39, s3, v97
    v_lshlrev_b32 v24, 16, v90
    v_lshlrev_b32 v40, 16, v98
    v_and_b32 v25, s3, v90
    v_and_b32 v41, s3, v98
    v_lshlrev_b32 v26, 16, v91
    v_lshlrev_b32 v42, 16, v99
    v_and_b32 v27, s3, v91
    v_and_b32 v43, s3, v99
    v_lshlrev_b32 v28, 16, v92
    v_lshlrev_b32 v44, 16, v64
    v_and_b32 v29, s3, v92
    v_and_b32 v45, s3, v64
    v_lshlrev_b32 v30, 16, v93
    v_lshlrev_b32 v46, 16, v65
    v_and_b32 v31, s3, v93
    v_and_b32 v47, s3, v65
    v_lshlrev_b32 v32, 16, v94
    v_lshlrev_b32 v48, 16, v66
    v_and_b32 v33, s3, v94
    v_and_b32 v49, s3, v66
    v_lshlrev_b32 v34, 16, v95
    v_lshlrev_b32 v50, 16, v67
    v_and_b32 v35, s3, v95
    v_and_b32 v51, s3, v67
    v_pk_add_f32 v[12:13], v[20:21], v[22:23]
    v_pk_add_f32 v[88:89], v[36:37], v[38:39]
    v_pk_add_f32 v[14:15], v[24:25], v[26:27]
    v_pk_add_f32 v[90:91], v[40:41], v[42:43]
    v_pk_add_f32 v[16:17], v[28:29], v[30:31]
    v_pk_add_f32 v[92:93], v[44:45], v[46:47]
    v_pk_add_f32 v[12:13], v[12:13], v[32:33]
    v_pk_add_f32 v[88:89], v[88:89], v[48:49]
    v_pk_add_f32 v[14:15], v[14:15], v[34:35]
    v_pk_add_f32 v[90:91], v[90:91], v[50:51]
    v_pk_add_f32 v[12:13], v[12:13], v[16:17]
    v_pk_add_f32 v[88:89], v[88:89], v[92:93]
    v_pk_add_f32 v[12:13], v[12:13], v[14:15]
    v_pk_add_f32 v[88:89], v[88:89], v[90:91]
    v_add_f32 v12, v12, v13
    v_add_f32 v88, v88, v89
    s_nop 0
    v_add_f32_dpp v12, v12, v12 quad_perm:[1,0,3,2] row_mask:0xf bank_mask:0xf
    v_add_f32_dpp v88, v88, v88 quad_perm:[1,0,3,2] row_mask:0xf bank_mask:0xf
    s_nop 0
    v_add_f32_dpp v12, v12, v12 quad_perm:[2,3,0,1] row_mask:0xf bank_mask:0xf
    v_add_f32_dpp v88, v88, v88 quad_perm:[2,3,0,1] row_mask:0xf bank_mask:0xf
    v_mul_f32 v12, 0xbc800000, v12
    v_mul_f32 v88, 0xbc800000, v88
    v_pk_add_f32 v[20:21], v[20:21], v[12:13] op_sel_hi:[1,0]
    v_pk_add_f32 v[36:37], v[36:37], v[88:89] op_sel_hi:[1,0]
    s_cbranch_scc0 KF_X2
    v_mov_b32 v18, 132392
    s_mov_b64 exec, 1
    s_waitcnt vmcnt(0)
    ds_add_rtn_u32 v19, v18, v8
    s_mov_b64 exec, -1
    buffer_store_dwordx4 v[52:55], v58, s[64:67], 0 offen sc1
KF_X2:
    v_pk_add_f32 v[22:23], v[22:23], v[12:13] op_sel_hi:[1,0]
    v_pk_add_f32 v[38:39], v[38:39], v[88:89] op_sel_hi:[1,0]
    v_pk_add_f32 v[24:25], v[24:25], v[12:13] op_sel_hi:[1,0]
    v_pk_add_f32 v[40:41], v[40:41], v[88:89] op_sel_hi:[1,0]
    v_pk_add_f32 v[26:27], v[26:27], v[12:13] op_sel_hi:[1,0]
    v_pk_add_f32 v[42:43], v[42:43], v[88:89] op_sel_hi:[1,0]
    v_pk_add_f32 v[28:29], v[28:29], v[12:13] op_sel_hi:[1,0]
    v_pk_add_f32 v[44:45], v[44:45], v[88:89] op_sel_hi:[1,0]
    v_pk_add_f32 v[30:31], v[30:31], v[12:13] op_sel_hi:[1,0]
    v_pk_add_f32 v[46:47], v[46:47], v[88:89] op_sel_hi:[1,0]
    v_pk_add_f32 v[32:33], v[32:33], v[12:13] op_sel_hi:[1,0]
    v_pk_add_f32 v[48:49], v[48:49], v[88:89] op_sel_hi:[1,0]
    v_pk_add_f32 v[34:35], v[34:35], v[12:13] op_sel_hi:[1,0]
    v_pk_add_f32 v[50:51], v[50:51], v[88:89] op_sel_hi:[1,0]
    v_pk_mul_f32 v[14:15], v[20:21], v[20:21]
    v_pk_mul_f32 v[90:91], v[36:37], v[36:37]
    v_pk_mul_f32 v[16:17], v[22:23], v[22:23]
    v_pk_mul_f32 v[92:93], v[38:39], v[38:39]
    s_cbranch_scc0 KF_X3
    s_waitcnt lgkmcnt(0)
    v_readfirstlane_b32 s16, v19
    s_mov_b64 exec, 1
    s_cmp_eq_u32 s16, 20
    s_cbranch_scc0 KF_X4
    global_store_dword v60, v8, s[4:5] sc1
KF_X4:
    s_mov_b64 exec, -1
KF_X3:
    v_pk_fma_f32 v[14:15], v[24:25], v[24:25], v[14:15]
    v_pk_fma_f32 v[90:91], v[40:41], v[40:41], v[90:91]
    v_pk_fma_f32 v[16:17], v[26:27], v[26:27], v[16:17]
    v_pk_fma_f32 v[92:93], v[42:43], v[42:43], v[92:93]
    v_pk_fma_f32 v[14:15], v[28:29], v[28:29], v[14:15]
    v_pk_fma_f32 v[90:91], v[44:45], v[44:45], v[90:91]
    v_pk_fma_f32 v[16:17], v[30:31], v[30:31], v[16:17]
    v_pk_fma_f32 v[92:93], v[46:47], v[46:47], v[92:93]
    v_pk_fma_f32 v[14:15], v[32:33], v[32:33], v[14:15]
    v_pk_fma_f32 v[90:91], v[48:49], v[48:49], v[90:91]
    v_pk_fma_f32 v[16:17], v[34:35], v[34:35], v[16:17]
    v_pk_fma_f32 v[92:93], v[50:51], v[50:51], v[92:93]
    v_pk_add_f32 v[14:15], v[14:15], v[16:17]
    v_pk_add_f32 v[90:91], v[90:91], v[92:93]
    v_add_f32 v12, v14, v15
    v_add_f32 v88, v90, v91
    s_nop 0
    v_add_f32_dpp v12, v12, v12 quad_perm:[1,0,3,2] row_mask:0xf bank_mask:0xf
    v_add_f32_dpp v88, v88, v88 quad_perm:[1,0,3,2] row_mask:0xf bank_mask:0xf
    s_nop 0
    v_add_f32_dpp v12, v12, v12 quad_perm:[2,3,0,1] row_mask:0xf bank_mask:0xf
    v_add_f32_dpp v88, v88, v88 quad_perm:[2,3,0,1] row_mask:0xf bank_mask:0xf
    v_mov_b32 v14, 0x3727c5ac
    v_mov_b32 v90, 0x3727c5ac
    v_fmac_f32 v14, 0x3c800000, v12
    v_fmac_f32 v90, 0x3c800000, v88
    v_rsq_f32 v12, v14
    v_rsq_f32 v88, v90
    v_pk_mul_f32 v[20:21], v[20:21], v[12:13] op_sel_hi:[1,0]
    v_pk_mul_f32 v[36:37], v[36:37], v[88:89] op_sel_hi:[1,0]
    v_pk_mul_f32 v[22:23], v[22:23], v[12:13] op_sel_hi:[1,0]
    v_pk_mul_f32 v[38:39], v[38:39], v[88:89] op_sel_hi:[1,0]
    v_pk_mul_f32 v[24:25], v[24:25], v[12:13] op_sel_hi:[1,0]
    v_pk_mul_f32 v[40:41], v[40:41], v[88:89] op_sel_hi:[1,0]
    v_pk_mul_f32 v[26:27], v[26:27], v[12:13] op_sel_hi:[1,0]
    v_pk_mul_f32 v[42:43], v[42:43], v[88:89] op_sel_hi:[1,0]
    v_pk_mul_f32 v[28:29], v[28:29], v[12:13] op_sel_hi:[1,0]
    v_pk_mul_f32 v[44:45], v[44:45], v[88:89] op_sel_hi:[1,0]
    v_pk_mul_f32 v[30:31], v[30:31], v[12:13] op_sel_hi:[1,0]
    v_pk_mul_f32 v[46:47], v[46:47], v[88:89] op_sel_hi:[1,0]
    v_pk_mul_f32 v[32:33], v[32:33], v[12:13] op_sel_hi:[1,0]
    v_pk_mul_f32 v[48:49], v[48:49], v[88:89] op_sel_hi:[1,0]
    v_pk_mul_f32 v[34:35], v[34:35], v[12:13] op_sel_hi:[1,0]
    v_pk_mul_f32 v[50:51], v[50:51], v[88:89] op_sel_hi:[1,0]
    v_cndmask_b32 v35, v35, 1.0, s[74:75]
    v_cndmask_b32 v51, v51, 1.0, s[74:75]
    v_cvt_pk_bf16_f32 v20, v20, v21
    v_cvt_pk_bf16_f32 v36, v36, v37
    v_cvt_pk_bf16_f32 v21, v22, v23
    v_cvt_pk_bf16_f32 v37, v38, v39
    v_cvt_pk_bf16_f32 v22, v24, v25
    v_cvt_pk_bf16_f32 v38, v40, v41
    v_cvt_pk_bf16_f32 v23, v26, v27
    v_cvt_pk_bf16_f32 v39, v42, v43
    ds_write_b128 v71, v[20:23]
    ds_write_b128 v71, v[36:39] offset:256
    v_cvt_pk_bf16_f32 v24, v28, v29
    v_cvt_pk_bf16_f32 v40, v44, v45
    v_cvt_pk_bf16_f32 v25, v30, v31
    v_cvt_pk_bf16_f32 v41, v46, v47
    v_cvt_pk_bf16_f32 v26, v32, v33
    v_cvt_pk_bf16_f32 v42, v48, v49
    v_cvt_pk_bf16_f32 v27, v34, v35
    v_cvt_pk_bf16_f32 v43, v50, v51
    ds_write_b128 v71, v[24:27] offset:2048
    ds_write_b128 v71, v[40:43] offset:2304
    s_waitcnt lgkmcnt(0)
    s_barrier
    s_setprio 2
    ds_read_b128 v[8:11], v68 offset:0
    ds_read_b128 v[72:75], v69 offset:0
    ds_read_b128 v[12:15], v68 offset:1024
    ds_read_b128 v[76:79], v70 offset:1024
    ds_read_b128 v[16:19], v68 offset:2048
    ds_read_b128 v[80:83], v69 offset:2048
    ds_read_b128 v[20:23], v68 offset:3072
    ds_read_b128 v[84:87], v70 offset:3072
    ds_read_b128 v[24:27], v68 offset:4096
    ds_read_b128 v[28:31], v68 offset:5120
    ds_read_b128 v[32:35], v68 offset:6144
    ds_read_b128 v[36:39], v68 offset:7168
    s_waitcnt lgkmcnt(10)
    v_mfma_f32_32x32x16_bf16 v[40:55], v[8:11], v[72:75], 0
    ds_read_b128 v[88:91], v57 offset:0
    s_waitcnt lgkmcnt(9)
    v_mfma_f32_32x32x16_bf16 v[40:55], v[12:15], v[76:79], v[40:55]
    ds_read_b128 v[92:95], v61 offset:1024
    s_waitcnt lgkmcnt(8)
    v_mfma_f32_32x32x16_bf16 v[40:55], v[16:19], v[80:83], v[40:55]
    ds_read_b128 v[96:99], v57 offset:2048
    s_waitcnt lgkmcnt(7)
    v_mfma_f32_32x32x16_bf16 v[40:55], v[20:23], v[84:87], v[40:55]
    ds_read_b128 v[100:103], v61 offset:3072
    s_waitcnt lgkmcnt(7)
    v_mfma_f32_32x32x16_bf16 v[56:71], v[24:27], v[72:75], 0
    s_waitcnt lgkmcnt(6)
    v_mfma_f32_32x32x16_bf16 v[56:71], v[28:31], v[76:79], v[56:71]
    s_waitcnt lgkmcnt(5)
    v_mfma_f32_32x32x16_bf16 v[56:71], v[32:35], v[80:83], v[56:71]
    s_waitcnt lgkmcnt(4)
    v_mfma_f32_32x32x16_bf16 v[56:71], v[36:39], v[84:87], v[56:71]
    s_nop 3
    v_cvt_pk_bf16_f32 v72, v40, v41
    v_cvt_pk_bf16_f32 v73, v42, v43
    v_cvt_pk_bf16_f32 v74, v44, v45
    v_cvt_pk_bf16_f32 v75, v46, v47
    v_cvt_pk_bf16_f32 v76, v48, v49
    v_cvt_pk_bf16_f32 v77, v50, v51
    v_cvt_pk_bf16_f32 v78, v52, v53
    v_cvt_pk_bf16_f32 v79, v54, v55
    s_waitcnt lgkmcnt(0)
    v_mfma_f32_32x32x16_bf16 v[40:55], v[8:11], v[88:91], 0
    ds_read_b128 v[8:11], v4 offset:0
    s_nop 0
    v_cvt_pk_bf16_f32 v80, v56, v57
    v_cvt_pk_bf16_f32 v81, v58, v59
    v_mfma_f32_32x32x16_bf16 v[40:55], v[12:15], v[92:95], v[40:55]
    ds_read_b128 v[12:15], v5 offset:1024
    v_cvt_pk_bf16_f32 v82, v60, v61
    v_cvt_pk_bf16_f32 v83, v62, v63
    v_mfma_f32_32x32x16_bf16 v[40:55], v[16:19], v[96:99], v[40:55]
    ds_read_b128 v[16:19], v4 offset:2048
    v_cvt_pk_bf16_f32 v84, v64, v65
    v_cvt_pk_bf16_f32 v85, v66, v67
    v_mfma_f32_32x32x16_bf16 v[40:55], v[20:23], v[100:103], v[40:55]
    ds_read_b128 v[20:23], v5 offset:3072
    v_cvt_pk_bf16_f32 v86, v68, v69
    v_cvt_pk_bf16_f32 v87, v70, v71
    v_mfma_f32_32x32x16_bf16 v[56:71], v[24:27], v[88:91], 0
    v_mfma_f32_32x32x16_bf16 v[56:71], v[28:31], v[92:95], v[56:71]
    v_mfma_f32_32x32x16_bf16 v[56:71], v[32:35], v[96:99], v[56:71]
    v_mfma_f32_32x32x16_bf16 v[56:71], v[36:39], v[100:103], v[56:71]
    v_mov_b32 v24, 132412
    s_mov_b64 exec, 1
    s_waitcnt vmcnt(0)
    ds_add_u32 v24, v7
    s_mov_b64 exec, -1
    s_nop 3
    v_cvt_pk_bf16_f32 v88, v40, v41
    v_cvt_pk_bf16_f32 v89, v42, v43
    v_cvt_pk_bf16_f32 v90, v44, v45
    v_cvt_pk_bf16_f32 v91, v46, v47
    v_cvt_pk_bf16_f32 v92, v48, v49
    v_cvt_pk_bf16_f32 v93, v50, v51
    v_cvt_pk_bf16_f32 v94, v52, v53
    v_cvt_pk_bf16_f32 v95, v54, v55
    v_mbcnt_lo_u32_b32 v4, -1, 0
    v_mbcnt_hi_u32_b32 v4, -1, v4
    v_and_b32 v5, 7, v4
    v_lshlrev_b32 v5, 5, v5
    v_add_u32 v5, 132112, v5
    s_lshl_b32 s16, s9, 2
    s_add_u32 s16, s16, 132448
    v_mov_b32 v26, s16
    v_cmp_gt_u32 vcc, 32, v4
    v_lshlrev_b32 v4, 4, v4
    s_lshl_b32 s16, s9, 13
    v_cndmask_b32 v5, v26, v5, vcc
    v_add_u32 v4, s16, v4
    s_cmp_eq_u32 s6, 7
    s_cbranch_scc1 KF_V_1
    s_cmp_eq_u32 s6, 1
    s_cbranch_scc1 KF_V_2
KF_V_0:
    s_waitcnt lgkmcnt(0)
    v_mfma_f32_32x32x16_bf16 v[40:55], v[8:11], v[72:75], 0
    v_cvt_pk_bf16_f32 v96, v56, v57
    v_cvt_pk_bf16_f32 v97, v58, v59
    v_mfma_f32_32x32x16_bf16 v[40:55], v[12:15], v[76:79], v[40:55]
    v_cvt_pk_bf16_f32 v98, v60, v61
    v_cvt_pk_bf16_f32 v99, v62, v63
    v_mfma_f32_32x32x16_bf16 v[40:55], v[16:19], v[80:83], v[40:55]
    v_cvt_pk_bf16_f32 v100, v64, v65
    v_cvt_pk_bf16_f32 v101, v66, v67
    v_mfma_f32_32x32x16_bf16 v[40:55], v[20:23], v[84:87], v[40:55]
    v_cvt_pk_bf16_f32 v102, v68, v69
    v_cvt_pk_bf16_f32 v103, v70, v71
    ds_read_b64_tr_b16 v[24:25], v2 offset:0
    ds_read_b64_tr_b16 v[26:27], v3 offset:0
    ds_read_b64_tr_b16 v[28:29], v2 offset:2048
    ds_read_b64_tr_b16 v[30:31], v3 offset:2048
    ds_read_b64_tr_b16 v[32:33], v2 offset:256
    ds_read_b64_tr_b16 v[34:35], v3 offset:256
    ds_read_b64_tr_b16 v[36:37], v2 offset:2304
    ds_read_b64_tr_b16 v[38:39], v3 offset:2304
    s_nop 1
    v_exp_f32 v40, v40
    v_exp_f32 v41, v41
    v_exp_f32 v42, v42
    v_exp_f32 v43, v43
    v_exp_f32 v44, v44
    v_exp_f32 v45, v45
    v_cvt_pk_bf16_f32 v40, v40, v41
    v_cvt_pk_bf16_f32 v41, v42, v43
.p2align 6
KF_LOOP_0:
    v_mfma_f32_32x32x16_bf16 v[56:71], v[8:11], v[88:91], 0
    v_cvt_pk_bf16_f32 v42, v44, v45
    ds_read_b128 v[8:11], v0 offset:4096
    v_exp_f32 v46, v46
    v_exp_f32 v47, v47
    v_mfma_f32_32x32x16_bf16 v[56:71], v[12:15], v[92:95], v[56:71]
    v_cvt_pk_bf16_f32 v43, v46, v47
    ds_read_b128 v[12:15], v1 offset:5120
    v_exp_f32 v48, v48
    v_exp_f32 v49, v49
    s_cmp_eq_u32 s20, 2
    s_cbranch_scc0 KF_BL0_0
    s_setprio 1
KF_BL0_0:
    v_mfma_f32_32x32x16_bf16 v[56:71], v[16:19], v[96:99], v[56:71]
    v_cvt_pk_bf16_f32 v48, v48, v49
    v_exp_f32 v50, v50
    v_exp_f32 v51, v51
    v_mfma_f32_32x32x16_bf16 v[56:71], v[20:23], v[100:103], v[56:71]
    v_cvt_pk_bf16_f32 v49, v50, v51
    ds_read_b128 v[20:23], v1 offset:7168
    v_exp_f32 v52, v52
    v_exp_f32 v53, v53
    s_waitcnt lgkmcnt(3)
    v_mfma_f32_32x32x16_bf16 v[104:119], v[24:27], v[40:43], v[104:119]
    v_cvt_pk_bf16_f32 v50, v52, v53
    v_exp_f32 v54, v54
    v_exp_f32 v55, v55
    v_mfma_f32_32x32x16_bf16 v[120:135], v[28:31], v[40:43], v[120:135]
    v_cvt_pk_bf16_f32 v51, v54, v55
    ds_read_b128 v[16:19], v0 offset:6144
    v_exp_f32 v56, v56
    v_exp_f32 v57, v57
    v_mfma_f32_32x32x16_bf16 v[104:119], v[32:35], v[48:51], v[104:119]
    v_cvt_pk_bf16_f32 v56, v56, v57
    v_exp_f32 v58, v58
    v_exp_f32 v59, v59
    v_mfma_f32_32x32x16_bf16 v[120:135], v[36:39], v[48:51], v[120:135]
    v_cvt_pk_bf16_f32 v57, v58, v59
    v_exp_f32 v60, v60
    v_exp_f32 v61, v61
    s_waitcnt lgkmcnt(0)
    v_mfma_f32_32x32x16_bf16 v[40:55], v[8:11], v[72:75], 0
    v_cvt_pk_bf16_f32 v58, v60, v61
    v_exp_f32 v62, v62
    v_exp_f32 v63, v63
    v_mfma_f32_32x32x16_bf16 v[40:55], v[12:15], v[76:79], v[40:55]
    v_cvt_pk_bf16_f32 v59, v62, v63
    v_exp_f32 v64, v64
    v_exp_f32 v65, v65
    v_mfma_f32_32x32x16_bf16 v[40:55], v[16:19], v[80:83], v[40:55]
    v_cvt_pk_bf16_f32 v64, v64, v65
    v_exp_f32 v66, v66
    v_exp_f32 v67, v67
    v_mfma_f32_32x32x16_bf16 v[40:55], v[20:23], v[84:87], v[40:55]
    v_cvt_pk_bf16_f32 v65, v66, v67
    v_exp_f32 v68, v68
    v_exp_f32 v69, v69
    v_mfma_f32_32x32x16_bf16 v[136:151], v[24:27], v[56:59], v[136:151]
    v_cvt_pk_bf16_f32 v66, v68, v69
    ds_read_b64_tr_b16 v[24:25], v2 offset:4096
    v_exp_f32 v70, v70
    ds_read_b64_tr_b16 v[26:27], v3 offset:4096
    v_exp_f32 v71, v71
    v_mfma_f32_32x32x16_bf16 v[152:167], v[28:31], v[56:59], v[152:167]
    v_cvt_pk_bf16_f32 v67, v70, v71
    ds_read_b64_tr_b16 v[28:29], v2 offset:6144
    v_exp_f32 v40, v40
    ds_read_b64_tr_b16 v[30:31], v3 offset:6144
    v_exp_f32 v41, v41
    v_mfma_f32_32x32x16_bf16 v[136:151], v[32:35], v[64:67], v[136:151]
    v_cvt_pk_bf16_f32 v40, v40, v41
    ds_read_b64_tr_b16 v[32:33], v2 offset:4352
    v_exp_f32 v42, v42
    ds_read_b64_tr_b16 v[34:35], v3 offset:4352
    v_exp_f32 v43, v43
    v_mfma_f32_32x32x16_bf16 v[152:167], v[36:39], v[64:67], v[152:167]
    v_cvt_pk_bf16_f32 v41, v42, v43
    ds_read_b64_tr_b16 v[36:37], v2 offset:6400
    v_exp_f32 v44, v44
    ds_read_b64_tr_b16 v[38:39], v3 offset:6400
    v_exp_f32 v45, v45
    v_mfma_f32_32x32x16_bf16 v[56:71], v[8:11], v[88:91], 0
    v_cvt_pk_bf16_f32 v42, v44, v45
    ds_read_b128 v[8:11], v0 offset:8192
    v_exp_f32 v46, v46
    v_exp_f32 v47, v47
    v_mfma_f32_32x32x16_bf16 v[56:71], v[12:15], v[92:95], v[56:71]
    v_cvt_pk_bf16_f32 v43, v46, v47
    ds_read_b128 v[12:15], v1 offset:9216
    v_exp_f32 v48, v48
    v_exp_f32 v49, v49
    v_mfma_f32_32x32x16_bf16 v[56:71], v[16:19], v[96:99], v[56:71]
    v_cvt_pk_bf16_f32 v48, v48, v49
    v_exp_f32 v50, v50
    v_exp_f32 v51, v51
    ds_read_b32 v44, v6
    v_mfma_f32_32x32x16_bf16 v[56:71], v[20:23], v[100:103], v[56:71]
    v_cvt_pk_bf16_f32 v49, v50, v51
    ds_read_b128 v[20:23], v1 offset:11264
    v_exp_f32 v52, v52
    v_exp_f32 v53, v53
    s_waitcnt lgkmcnt(4)
    v_mfma_f32_32x32x16_bf16 v[104:119], v[24:27], v[40:43], v[104:119]
    v_cvt_pk_bf16_f32 v50, v52, v53
    v_exp_f32 v54, v54
    v_exp_f32 v55, v55
    v_mfma_f32_32x32x16_bf16 v[120:135], v[28:31], v[40:43], v[120:135]
    v_cvt_pk_bf16_f32 v51, v54, v55
    ds_read_b128 v[16:19], v0 offset:10240
    v_exp_f32 v56, v56
    v_exp_f32 v57, v57
    v_mfma_f32_32x32x16_bf16 v[104:119], v[32:35], v[48:51], v[104:119]
    v_cvt_pk_bf16_f32 v56, v56, v57
    v_exp_f32 v58, v58
    v_exp_f32 v59, v59
    v_mfma_f32_32x32x16_bf16 v[120:135], v[36:39], v[48:51], v[120:135]
    v_cvt_pk_bf16_f32 v57, v58, v59
    v_exp_f32 v60, v60
    v_exp_f32 v61, v61
    s_waitcnt lgkmcnt(0)
    v_cmp_ge_u32 vcc, v7, v44
    v_mfma_f32_32x32x16_bf16 v[40:55], v[8:11], v[72:75], 0
    v_cvt_pk_bf16_f32 v58, v60, v61
    s_cbranch_vccnz KF_SPIN3_0
KF_GO3_0:
    ds_read_b128 v[8:11], v0 offset:32768
    v_exp_f32 v62, v62
    v_exp_f32 v63, v63
    v_mfma_f32_32x32x16_bf16 v[40:55], v[12:15], v[76:79], v[40:55]
    v_cvt_pk_bf16_f32 v59, v62, v63
    ds_read_b128 v[12:15], v1 offset:33792
    v_exp_f32 v64, v64
    v_exp_f32 v65, v65
    v_mfma_f32_32x32x16_bf16 v[40:55], v[16:19], v[80:83], v[40:55]
    v_cvt_pk_bf16_f32 v64, v64, v65
    ds_read_b128 v[16:19], v0 offset:34816
    v_exp_f32 v66, v66
    v_exp_f32 v67, v67
    v_mfma_f32_32x32x16_bf16 v[40:55], v[20:23], v[84:87], v[40:55]
    v_cvt_pk_bf16_f32 v65, v66, v67
    ds_read_b128 v[20:23], v1 offset:35840
    v_exp_f32 v68, v68
    v_exp_f32 v69, v69
    v_mfma_f32_32x32x16_bf16 v[136:151], v[24:27], v[56:59], v[136:151]
    v_cvt_pk_bf16_f32 v66, v68, v69
    ds_read_b64_tr_b16 v[24:25], v2 offset:8192
    v_exp_f32 v70, v70
    ds_read_b64_tr_b16 v[26:27], v3 offset:8192
    v_exp_f32 v71, v71
    v_mfma_f32_32x32x16_bf16 v[152:167], v[28:31], v[56:59], v[152:167]
    v_cvt_pk_bf16_f32 v67, v70, v71
    ds_read_b64_tr_b16 v[28:29], v2 offset:10240
    v_exp_f32 v40, v40
    ds_read_b64_tr_b16 v[30:31], v3 offset:10240
    v_exp_f32 v41, v41
    v_mfma_f32_32x32x16_bf16 v[136:151], v[32:35], v[64:67], v[136:151]
    v_cvt_pk_bf16_f32 v40, v40, v41
    ds_read_b64_tr_b16 v[32:33], v2 offset:8448
    v_exp_f32 v42, v42
    ds_read_b64_tr_b16 v[34:35], v3 offset:8448
    v_exp_f32 v43, v43
    v_mfma_f32_32x32x16_bf16 v[152:167], v[36:39], v[64:67], v[152:167]
    v_cvt_pk_bf16_f32 v41, v42, v43
    ds_read_b64_tr_b16 v[36:37], v2 offset:10496
    v_exp_f32 v44, v44
    ds_read_b64_tr_b16 v[38:39], v3 offset:10496
    v_exp_f32 v45, v45
    s_waitcnt lgkmcnt(8)
    v_mfma_f32_32x32x16_bf16 v[56:71], v[8:11], v[72:75], 0
    v_cvt_pk_bf16_f32 v42, v44, v45
    v_exp_f32 v46, v46
    v_exp_f32 v47, v47
    v_mfma_f32_32x32x16_bf16 v[56:71], v[12:15], v[76:79], v[56:71]
    v_cvt_pk_bf16_f32 v43, v46, v47
    v_exp_f32 v48, v48
    v_exp_f32 v49, v49
    v_mfma_f32_32x32x16_bf16 v[56:71], v[16:19], v[80:83], v[56:71]
    v_cvt_pk_bf16_f32 v48, v48, v49
    v_exp_f32 v50, v50
    v_exp_f32 v51, v51
    v_mfma_f32_32x32x16_bf16 v[56:71], v[20:23], v[84:87], v[56:71]
    v_cvt_pk_bf16_f32 v49, v50, v51
    v_exp_f32 v52, v52
    v_exp_f32 v53, v53
    s_waitcnt lgkmcnt(0)
    v_mfma_f32_32x32x16_bf16 v[104:119], v[24:27], v[40:43], v[104:119]
    v_cvt_pk_bf16_f32 v50, v52, v53
    ds_write_b32 v6, v7 offset:16
    ds_read_b64_tr_b16 v[24:25], v2 offset:32768
    v_exp_f32 v54, v54
    ds_read_b64_tr_b16 v[26:27], v3 offset:32768
    v_exp_f32 v55, v55
    v_mfma_f32_32x32x16_bf16 v[120:135], v[28:31], v[40:43], v[120:135]
    v_cvt_pk_bf16_f32 v51, v54, v55
    ds_read_b64_tr_b16 v[28:29], v2 offset:34816
    v_exp_f32 v56, v56
    ds_read_b64_tr_b16 v[30:31], v3 offset:34816
    v_exp_f32 v57, v57
    v_mfma_f32_32x32x16_bf16 v[104:119], v[32:35], v[48:51], v[104:119]
    v_cvt_pk_bf16_f32 v56, v56, v57
    ds_read_b64_tr_b16 v[32:33], v2 offset:33024
    v_exp_f32 v58, v58
    ds_read_b64_tr_b16 v[34:35], v3 offset:33024
    v_exp_f32 v59, v59
    v_mfma_f32_32x32x16_bf16 v[120:135], v[36:39], v[48:51], v[120:135]
    v_cvt_pk_bf16_f32 v57, v58, v59
    ds_read_b64_tr_b16 v[36:37], v2 offset:35072
    v_exp_f32 v60, v60
    ds_read_b64_tr_b16 v[38:39], v3 offset:35072
    v_exp_f32 v61, v61
    v_add_u32 v7, 1, v7
    v_mfma_f32_32x32x16_bf16 v[40:55], v[8:11], v[88:91], 0
    v_cvt_pk_bf16_f32 v58, v60, v61
    ds_read_b128 v[8:11], v0 offset:36864
    v_exp_f32 v62, v62
    v_exp_f32 v63, v63
    v_mfma_f32_32x32x16_bf16 v[40:55], v[12:15], v[92:95], v[40:55]
    v_cvt_pk_bf16_f32 v59, v62, v63
    ds_read_b128 v[12:15], v1 offset:37888
    v_exp_f32 v64, v64
    v_exp_f32 v65, v65
    s_cmp_eq_u32 s20, 1
    s_cbranch_scc0 KF_BL5_0
    s_setprio 0
KF_BL5_0:
    v_mfma_f32_32x32x16_bf16 v[40:55], v[16:19], v[96:99], v[40:55]
    v_cvt_pk_bf16_f32 v64, v64, v65
    v_exp_f32 v66, v66
    v_exp_f32 v67, v67
    v_mfma_f32_32x32x16_bf16 v[40:55], v[20:23], v[100:103], v[40:55]
    v_cvt_pk_bf16_f32 v65, v66, v67
    ds_read_b128 v[20:23], v1 offset:39936
    v_exp_f32 v68, v68
    v_exp_f32 v69, v69
    s_waitcnt lgkmcnt(3)
    v_mfma_f32_32x32x16_bf16 v[104:119], v[24:27], v[56:59], v[104:119]
    v_cvt_pk_bf16_f32 v66, v68, v69
    v_exp_f32 v70, v70
    v_exp_f32 v71, v71
    v_mfma_f32_32x32x16_bf16 v[120:135], v[28:31], v[56:59], v[120:135]
    v_cvt_pk_bf16_f32 v67, v70, v71
    ds_read_b128 v[16:19], v0 offset:38912
    v_exp_f32 v40, v40
    v_exp_f32 v41, v41
    v_mfma_f32_32x32x16_bf16 v[104:119], v[32:35], v[64:67], v[104:119]
    v_cvt_pk_bf16_f32 v40, v40, v41
    v_exp_f32 v42, v42
    v_exp_f32 v43, v43
    v_mfma_f32_32x32x16_bf16 v[120:135], v[36:39], v[64:67], v[120:135]
    v_cvt_pk_bf16_f32 v41, v42, v43
    v_exp_f32 v44, v44
    v_exp_f32 v45, v45
    s_waitcnt lgkmcnt(0)
    v_mfma_f32_32x32x16_bf16 v[56:71], v[8:11], v[72:75], 0
    v_cvt_pk_bf16_f32 v42, v44, v45
    v_exp_f32 v46, v46
    v_exp_f32 v47, v47
    v_mfma_f32_32x32x16_bf16 v[56:71], v[12:15], v[76:79], v[56:71]
    v_cvt_pk_bf16_f32 v43, v46, v47
    v_exp_f32 v48, v48
    v_exp_f32 v49, v49
    v_mfma_f32_32x32x16_bf16 v[56:71], v[16:19], v[80:83], v[56:71]
    v_cvt_pk_bf16_f32 v48, v48, v49
    v_exp_f32 v50, v50
    v_exp_f32 v51, v51
    v_mfma_f32_32x32x16_bf16 v[56:71], v[20:23], v[84:87], v[56:71]
    v_cvt_pk_bf16_f32 v49, v50, v51
    v_exp_f32 v52, v52
    v_exp_f32 v53, v53
    v_mfma_f32_32x32x16_bf16 v[136:151], v[24:27], v[40:43], v[136:151]
    v_cvt_pk_bf16_f32 v50, v52, v53
    ds_read_b64_tr_b16 v[24:25], v2 offset:36864
    v_exp_f32 v54, v54
    ds_read_b64_tr_b16 v[26:27], v3 offset:36864
    v_exp_f32 v55, v55
    v_mfma_f32_32x32x16_bf16 v[152:167], v[28:31], v[40:43], v[152:167]
    v_cvt_pk_bf16_f32 v51, v54, v55
    ds_read_b64_tr_b16 v[28:29], v2 offset:38912
    v_exp_f32 v56, v56
    ds_read_b64_tr_b16 v[30:31], v3 offset:38912
    v_exp_f32 v57, v57
    v_mfma_f32_32x32x16_bf16 v[136:151], v[32:35], v[48:51], v[136:151]
    v_cvt_pk_bf16_f32 v56, v56, v57
    ds_read_b64_tr_b16 v[32:33], v2 offset:37120
    v_exp_f32 v58, v58
    ds_read_b64_tr_b16 v[34:35], v3 offset:37120
    v_exp_f32 v59, v59
    v_mfma_f32_32x32x16_bf16 v[152:167], v[36:39], v[48:51], v[152:167]
    v_cvt_pk_bf16_f32 v57, v58, v59
    ds_read_b64_tr_b16 v[36:37], v2 offset:39168
    v_exp_f32 v60, v60
    ds_read_b64_tr_b16 v[38:39], v3 offset:39168
    v_exp_f32 v61, v61
    v_mfma_f32_32x32x16_bf16 v[40:55], v[8:11], v[88:91], 0
    v_cvt_pk_bf16_f32 v58, v60, v61
    ds_read_b128 v[8:11], v0 offset:40960
    v_exp_f32 v62, v62
    v_exp_f32 v63, v63
    v_mfma_f32_32x32x16_bf16 v[40:55], v[12:15], v[92:95], v[40:55]
    v_cvt_pk_bf16_f32 v59, v62, v63
    ds_read_b128 v[12:15], v1 offset:41984
    v_exp_f32 v64, v64
    v_exp_f32 v65, v65
    v_mfma_f32_32x32x16_bf16 v[40:55], v[16:19], v[96:99], v[40:55]
    v_cvt_pk_bf16_f32 v64, v64, v65
    v_exp_f32 v66, v66
    v_exp_f32 v67, v67
    ds_read_b32 v60, v6
    v_mfma_f32_32x32x16_bf16 v[40:55], v[20:23], v[100:103], v[40:55]
    v_cvt_pk_bf16_f32 v65, v66, v67
    ds_read_b128 v[20:23], v1 offset:44032
    v_exp_f32 v68, v68
    v_exp_f32 v69, v69
    s_waitcnt lgkmcnt(4)
    v_mfma_f32_32x32x16_bf16 v[104:119], v[24:27], v[56:59], v[104:119]
    v_cvt_pk_bf16_f32 v66, v68, v69
    v_exp_f32 v70, v70
    v_exp_f32 v71, v71
    v_mfma_f32_32x32x16_bf16 v[120:135], v[28:31], v[56:59], v[120:135]
    v_cvt_pk_bf16_f32 v67, v70, v71
    ds_read_b128 v[16:19], v0 offset:43008
    v_exp_f32 v40, v40
    v_exp_f32 v41, v41
    v_mfma_f32_32x32x16_bf16 v[104:119], v[32:35], v[64:67], v[104:119]
    v_cvt_pk_bf16_f32 v40, v40, v41
    v_exp_f32 v42, v42
    v_exp_f32 v43, v43
    v_xor_b32 v0, 0x10000, v0
    v_mfma_f32_32x32x16_bf16 v[120:135], v[36:39], v[64:67], v[120:135]
    v_cvt_pk_bf16_f32 v41, v42, v43
    v_exp_f32 v44, v44
    v_exp_f32 v45, v45
    v_xor_b32 v1, 0x10000, v1
    s_waitcnt lgkmcnt(0)
    v_cmp_ge_u32 vcc, v7, v60
    v_mfma_f32_32x32x16_bf16 v[56:71], v[8:11], v[72:75], 0
    v_cvt_pk_bf16_f32 v42, v44, v45
    s_cbranch_vccnz KF_SPIN8_0
KF_GO8_0:
    ds_read_b128 v[8:11], v0 offset:0
    v_exp_f32 v46, v46
    v_exp_f32 v47, v47
    v_mfma_f32_32x32x16_bf16 v[56:71], v[12:15], v[76:79], v[56:71]
    v_cvt_pk_bf16_f32 v43, v46, v47
    ds_read_b128 v[12:15], v1 offset:1024
    v_exp_f32 v48, v48
    v_exp_f32 v49, v49
    v_mfma_f32_32x32x16_bf16 v[56:71], v[16:19], v[80:83], v[56:71]
    v_cvt_pk_bf16_f32 v48, v48, v49
    ds_read_b128 v[16:19], v0 offset:2048
    v_exp_f32 v50, v50
    v_exp_f32 v51, v51
    v_mfma_f32_32x32x16_bf16 v[56:71], v[20:23], v[84:87], v[56:71]
    v_cvt_pk_bf16_f32 v49, v50, v51
    ds_read_b128 v[20:23], v1 offset:3072
    v_exp_f32 v52, v52
    v_exp_f32 v53, v53
    v_mfma_f32_32x32x16_bf16 v[136:151], v[24:27], v[40:43], v[136:151]
    v_cvt_pk_bf16_f32 v50, v52, v53
    ds_read_b64_tr_b16 v[24:25], v2 offset:40960
    v_exp_f32 v54, v54
    ds_read_b64_tr_b16 v[26:27], v3 offset:40960
    v_exp_f32 v55, v55
    v_mfma_f32_32x32x16_bf16 v[152:167], v[28:31], v[40:43], v[152:167]
    v_cvt_pk_bf16_f32 v51, v54, v55
    ds_read_b64_tr_b16 v[28:29], v2 offset:43008
    v_exp_f32 v56, v56
    ds_read_b64_tr_b16 v[30:31], v3 offset:43008
    v_exp_f32 v57, v57
    v_mfma_f32_32x32x16_bf16 v[136:151], v[32:35], v[48:51], v[136:151]
    v_cvt_pk_bf16_f32 v56, v56, v57
    ds_read_b64_tr_b16 v[32:33], v2 offset:41216
    v_exp_f32 v58, v58
    ds_read_b64_tr_b16 v[34:35], v3 offset:41216
    v_exp_f32 v59, v59
    v_mfma_f32_32x32x16_bf16 v[152:167], v[36:39], v[48:51], v[152:167]
    v_cvt_pk_bf16_f32 v57, v58, v59
    ds_read_b64_tr_b16 v[36:37], v2 offset:43264
    v_exp_f32 v60, v60
    ds_read_b64_tr_b16 v[38:39], v3 offset:43264
    v_exp_f32 v61, v61
    s_waitcnt lgkmcnt(8)
    v_mfma_f32_32x32x16_bf16 v[40:55], v[8:11], v[72:75], 0
    v_cvt_pk_bf16_f32 v58, v60, v61
    v_exp_f32 v62, v62
    v_exp_f32 v63, v63
    v_mfma_f32_32x32x16_bf16 v[40:55], v[12:15], v[76:79], v[40:55]
    v_cvt_pk_bf16_f32 v59, v62, v63
    v_exp_f32 v64, v64
    v_exp_f32 v65, v65
    v_xor_b32 v2, 0x10000, v2
    v_mfma_f32_32x32x16_bf16 v[40:55], v[16:19], v[80:83], v[40:55]
    v_cvt_pk_bf16_f32 v64, v64, v65
    v_exp_f32 v66, v66
    v_exp_f32 v67, v67
    v_xor_b32 v3, 0x10000, v3
    v_mfma_f32_32x32x16_bf16 v[40:55], v[20:23], v[84:87], v[40:55]
    v_cvt_pk_bf16_f32 v65, v66, v67
    v_exp_f32 v68, v68
    v_exp_f32 v69, v69
    s_waitcnt lgkmcnt(0)
    v_mfma_f32_32x32x16_bf16 v[104:119], v[24:27], v[56:59], v[104:119]
    v_cvt_pk_bf16_f32 v66, v68, v69
    ds_write_b32 v6, v7 offset:16
    ds_read_b64_tr_b16 v[24:25], v2 offset:0
    v_exp_f32 v70, v70
    ds_read_b64_tr_b16 v[26:27], v3 offset:0
    v_exp_f32 v71, v71
    v_mfma_f32_32x32x16_bf16 v[120:135], v[28:31], v[56:59], v[120:135]
    v_cvt_pk_bf16_f32 v67, v70, v71
    ds_read_b64_tr_b16 v[28:29], v2 offset:2048
    v_exp_f32 v40, v40
    ds_read_b64_tr_b16 v[30:31], v3 offset:2048
    v_exp_f32 v41, v41
    s_sub_u32 s20, s20, 1
    v_mfma_f32_32x32x16_bf16 v[104:119], v[32:35], v[64:67], v[104:119]
    v_cvt_pk_bf16_f32 v40, v40, v41
    ds_read_b64_tr_b16 v[32:33], v2 offset:256
    v_exp_f32 v42, v42
    ds_read_b64_tr_b16 v[34:35], v3 offset:256
    v_exp_f32 v43, v43
    s_cmp_lg_u32 s20, 0
    v_mfma_f32_32x32x16_bf16 v[120:135], v[36:39], v[64:67], v[120:135]
    v_cvt_pk_bf16_f32 v41, v42, v43
    ds_read_b64_tr_b16 v[36:37], v2 offset:2304
    v_exp_f32 v44, v44
    ds_read_b64_tr_b16 v[38:39], v3 offset:2304
    v_exp_f32 v45, v45
    v_add_u32 v7, 1, v7
    s_cbranch_scc1 KF_LOOP_0
    s_branch KF_LE
KF_V_1:
    s_waitcnt lgkmcnt(0)
    v_mfma_f32_32x32x16_bf16 v[40:55], v[8:11], v[72:75], 0
    v_cvt_pk_bf16_f32 v96, v56, v57
    v_cvt_pk_bf16_f32 v97, v58, v59
    v_mfma_f32_32x32x16_bf16 v[40:55], v[12:15], v[76:79], v[40:55]
    v_cvt_pk_bf16_f32 v98, v60, v61
    v_cvt_pk_bf16_f32 v99, v62, v63
    v_mfma_f32_32x32x16_bf16 v[40:55], v[16:19], v[80:83], v[40:55]
    v_cvt_pk_bf16_f32 v100, v64, v65
    v_cvt_pk_bf16_f32 v101, v66, v67
    v_mfma_f32_32x32x16_bf16 v[40:55], v[20:23], v[84:87], v[40:55]
    v_cvt_pk_bf16_f32 v102, v68, v69
    v_cvt_pk_bf16_f32 v103, v70, v71
    ds_read_b64_tr_b16 v[24:25], v2 offset:24576
    ds_read_b64_tr_b16 v[26:27], v3 offset:24576
    ds_read_b64_tr_b16 v[28:29], v2 offset:26624
    ds_read_b64_tr_b16 v[30:31], v3 offset:26624
    ds_read_b64_tr_b16 v[32:33], v2 offset:24832
    ds_read_b64_tr_b16 v[34:35], v3 offset:24832
    ds_read_b64_tr_b16 v[36:37], v2 offset:26880
    ds_read_b64_tr_b16 v[38:39], v3 offset:26880
    s_nop 1
    v_exp_f32 v40, v40
    v_exp_f32 v41, v41
    v_exp_f32 v42, v42
    v_exp_f32 v43, v43
    v_exp_f32 v44, v44
    v_exp_f32 v45, v45
    v_cvt_pk_bf16_f32 v40, v40, v41
    v_cvt_pk_bf16_f32 v41, v42, v43
.p2align 6
KF_LOOP_1:
    v_mfma_f32_32x32x16_bf16 v[56:71], v[8:11], v[88:91], 0
    v_cvt_pk_bf16_f32 v42, v44, v45
    ds_read_b128 v[8:11], v0 offset:28672
    v_exp_f32 v46, v46
    v_exp_f32 v47, v47
    v_mfma_f32_32x32x16_bf16 v[56:71], v[12:15], v[92:95], v[56:71]
    v_cvt_pk_bf16_f32 v43, v46, v47
    ds_read_b128 v[12:15], v1 offset:29696
    v_exp_f32 v48, v48
    v_exp_f32 v49, v49
    s_cmp_eq_u32 s20, 2
    s_cbranch_scc0 KF_BL0_1
    s_setprio 1
KF_BL0_1:
    v_mfma_f32_32x32x16_bf16 v[56:71], v[16:19], v[96:99], v[56:71]
    v_cvt_pk_bf16_f32 v48, v48, v49
    v_exp_f32 v50, v50
    v_exp_f32 v51, v51
    v_mfma_f32_32x32x16_bf16 v[56:71], v[20:23], v[100:103], v[56:71]
    v_cvt_pk_bf16_f32 v49, v50, v51
    ds_read_b128 v[20:23], v1 offset:31744
    v_exp_f32 v52, v52
    v_exp_f32 v53, v53
    s_waitcnt lgkmcnt(3)
    v_mfma_f32_32x32x16_bf16 v[104:119], v[24:27], v[40:43], v[104:119]
    v_cvt_pk_bf16_f32 v50, v52, v53
    v_exp_f32 v54, v54
    v_exp_f32 v55, v55
    v_mfma_f32_32x32x16_bf16 v[120:135], v[28:31], v[40:43], v[120:135]
    v_cvt_pk_bf16_f32 v51, v54, v55
    ds_read_b128 v[16:19], v0 offset:30720
    v_exp_f32 v56, v56
    v_exp_f32 v57, v57
    v_mfma_f32_32x32x16_bf16 v[104:119], v[32:35], v[48:51], v[104:119]
    v_cvt_pk_bf16_f32 v56, v56, v57
    v_exp_f32 v58, v58
    v_exp_f32 v59, v59
    v_mfma_f32_32x32x16_bf16 v[120:135], v[36:39], v[48:51], v[120:135]
    v_cvt_pk_bf16_f32 v57, v58, v59
    v_exp_f32 v60, v60
    v_exp_f32 v61, v61
    s_waitcnt lgkmcnt(0)
    v_mfma_f32_32x32x16_bf16 v[40:55], v[8:11], v[72:75], 0
    v_cvt_pk_bf16_f32 v58, v60, v61
    v_exp_f32 v62, v62
    v_exp_f32 v63, v63
    v_mfma_f32_32x32x16_bf16 v[40:55], v[12:15], v[76:79], v[40:55]
    v_cvt_pk_bf16_f32 v59, v62, v63
    v_exp_f32 v64, v64
    v_exp_f32 v65, v65
    v_mfma_f32_32x32x16_bf16 v[40:55], v[16:19], v[80:83], v[40:55]
    v_cvt_pk_bf16_f32 v64, v64, v65
    v_exp_f32 v66, v66
    v_exp_f32 v67, v67
    v_mfma_f32_32x32x16_bf16 v[40:55], v[20:23], v[84:87], v[40:55]
    v_cvt_pk_bf16_f32 v65, v66, v67
    v_exp_f32 v68, v68
    v_exp_f32 v69, v69
    v_mfma_f32_32x32x16_bf16 v[136:151], v[24:27], v[56:59], v[136:151]
    v_cvt_pk_bf16_f32 v66, v68, v69
    ds_read_b64_tr_b16 v[24:25], v2 offset:28672
    v_exp_f32 v70, v70
    ds_read_b64_tr_b16 v[26:27], v3 offset:28672
    v_exp_f32 v71, v71
    v_mfma_f32_32x32x16_bf16 v[152:167], v[28:31], v[56:59], v[152:167]
    v_cvt_pk_bf16_f32 v67, v70, v71
    ds_read_b64_tr_b16 v[28:29], v2 offset:30720
    v_exp_f32 v40, v40
    ds_read_b64_tr_b16 v[30:31], v3 offset:30720
    v_exp_f32 v41, v41
    v_mfma_f32_32x32x16_bf16 v[136:151], v[32:35], v[64:67], v[136:151]
    v_cvt_pk_bf16_f32 v40, v40, v41
    ds_read_b64_tr_b16 v[32:33], v2 offset:28928
    v_exp_f32 v42, v42
    ds_read_b64_tr_b16 v[34:35], v3 offset:28928
    v_exp_f32 v43, v43
    v_mfma_f32_32x32x16_bf16 v[152:167], v[36:39], v[64:67], v[152:167]
    v_cvt_pk_bf16_f32 v41, v42, v43
    ds_read_b64_tr_b16 v[36:37], v2 offset:30976
    v_exp_f32 v44, v44
    ds_read_b64_tr_b16 v[38:39], v3 offset:30976
    v_exp_f32 v45, v45
    v_mfma_f32_32x32x16_bf16 v[56:71], v[8:11], v[88:91], 0
    v_cvt_pk_bf16_f32 v42, v44, v45
    ds_read_b128 v[8:11], v0 offset:0
    v_exp_f32 v46, v46
    v_exp_f32 v47, v47
    v_mfma_f32_32x32x16_bf16 v[56:71], v[12:15], v[92:95], v[56:71]
    v_cvt_pk_bf16_f32 v43, v46, v47
    ds_read_b128 v[12:15], v1 offset:1024
    v_exp_f32 v48, v48
    v_exp_f32 v49, v49
    v_mfma_f32_32x32x16_bf16 v[56:71], v[16:19], v[96:99], v[56:71]
    v_cvt_pk_bf16_f32 v48, v48, v49
    v_exp_f32 v50, v50
    v_exp_f32 v51, v51
    ds_read_b32 v44, v6
    v_mfma_f32_32x32x16_bf16 v[56:71], v[20:23], v[100:103], v[56:71]
    v_cvt_pk_bf16_f32 v49, v50, v51
    ds_read_b128 v[20:23], v1 offset:3072
    v_exp_f32 v52, v52
    v_exp_f32 v53, v53
    s_waitcnt lgkmcnt(4)
    v_mfma_f32_32x32x16_bf16 v[104:119], v[24:27], v[40:43], v[104:119]
    v_cvt_pk_bf16_f32 v50, v52, v53
    v_exp_f32 v54, v54
    v_exp_f32 v55, v55
    v_mfma_f32_32x32x16_bf16 v[120:135], v[28:31], v[40:43], v[120:135]
    v_cvt_pk_bf16_f32 v51, v54, v55
    ds_read_b128 v[16:19], v0 offset:2048
    v_exp_f32 v56, v56
    v_exp_f32 v57, v57
    v_mfma_f32_32x32x16_bf16 v[104:119], v[32:35], v[48:51], v[104:119]
    v_cvt_pk_bf16_f32 v56, v56, v57
    v_exp_f32 v58, v58
    v_exp_f32 v59, v59
    v_mfma_f32_32x32x16_bf16 v[120:135], v[36:39], v[48:51], v[120:135]
    v_cvt_pk_bf16_f32 v57, v58, v59
    v_exp_f32 v60, v60
    v_exp_f32 v61, v61
    s_waitcnt lgkmcnt(0)
    v_cmp_ge_u32 vcc, v7, v44
    v_mfma_f32_32x32x16_bf16 v[40:55], v[8:11], v[72:75], 0
    v_cvt_pk_bf16_f32 v58, v60, v61
    s_cbranch_vccnz KF_SPIN3_1
KF_GO3_1:
    ds_read_b128 v[8:11], v0 offset:57344
    v_exp_f32 v62, v62
    v_exp_f32 v63, v63
    v_mfma_f32_32x32x16_bf16 v[40:55], v[12:15], v[76:79], v[40:55]
    v_cvt_pk_bf16_f32 v59, v62, v63
    ds_read_b128 v[12:15], v1 offset:58368
    v_exp_f32 v64, v64
    v_exp_f32 v65, v65
    v_mfma_f32_32x32x16_bf16 v[40:55], v[16:19], v[80:83], v[40:55]
    v_cvt_pk_bf16_f32 v64, v64, v65
    ds_read_b128 v[16:19], v0 offset:59392
    v_exp_f32 v66, v66
    v_exp_f32 v67, v67
    v_mfma_f32_32x32x16_bf16 v[40:55], v[20:23], v[84:87], v[40:55]
    v_cvt_pk_bf16_f32 v65, v66, v67
    ds_read_b128 v[20:23], v1 offset:60416
    v_exp_f32 v68, v68
    v_exp_f32 v69, v69
    v_mfma_f32_32x32x16_bf16 v[136:151], v[24:27], v[56:59], v[136:151]
    v_cvt_pk_bf16_f32 v66, v68, v69
    ds_read_b64_tr_b16 v[24:25], v2 offset:0
    v_exp_f32 v70, v70
    ds_read_b64_tr_b16 v[26:27], v3 offset:0
    v_exp_f32 v71, v71
    v_mfma_f32_32x32x16_bf16 v[152:167], v[28:31], v[56:59], v[152:167]
    v_cvt_pk_bf16_f32 v67, v70, v71
    ds_read_b64_tr_b16 v[28:29], v2 offset:2048
    v_exp_f32 v40, v40
    ds_read_b64_tr_b16 v[30:31], v3 offset:2048
    v_exp_f32 v41, v41
    v_mfma_f32_32x32x16_bf16 v[136:151], v[32:35], v[64:67], v[136:151]
    v_cvt_pk_bf16_f32 v40, v40, v41
    ds_read_b64_tr_b16 v[32:33], v2 offset:256
    v_exp_f32 v42, v42
    ds_read_b64_tr_b16 v[34:35], v3 offset:256
    v_exp_f32 v43, v43
    v_mfma_f32_32x32x16_bf16 v[152:167], v[36:39], v[64:67], v[152:167]
    v_cvt_pk_bf16_f32 v41, v42, v43
    ds_read_b64_tr_b16 v[36:37], v2 offset:2304
    v_exp_f32 v44, v44
    ds_read_b64_tr_b16 v[38:39], v3 offset:2304
    v_exp_f32 v45, v45
    s_waitcnt lgkmcnt(8)
    v_mfma_f32_32x32x16_bf16 v[56:71], v[8:11], v[72:75], 0
    v_cvt_pk_bf16_f32 v42, v44, v45
    v_exp_f32 v46, v46
    v_exp_f32 v47, v47
    v_mfma_f32_32x32x16_bf16 v[56:71], v[12:15], v[76:79], v[56:71]
    v_cvt_pk_bf16_f32 v43, v46, v47
    v_exp_f32 v48, v48
    v_exp_f32 v49, v49
    v_mfma_f32_32x32x16_bf16 v[56:71], v[16:19], v[80:83], v[56:71]
    v_cvt_pk_bf16_f32 v48, v48, v49
    v_exp_f32 v50, v50
    v_exp_f32 v51, v51
    v_mfma_f32_32x32x16_bf16 v[56:71], v[20:23], v[84:87], v[56:71]
    v_cvt_pk_bf16_f32 v49, v50, v51
    v_exp_f32 v52, v52
    v_exp_f32 v53, v53
    s_waitcnt lgkmcnt(0)
    v_mfma_f32_32x32x16_bf16 v[104:119], v[24:27], v[40:43], v[104:119]
    v_cvt_pk_bf16_f32 v50, v52, v53
    ds_write_b32 v6, v7 offset:16
    ds_read_b64_tr_b16 v[24:25], v2 offset:57344
    v_exp_f32 v54, v54
    ds_read_b64_tr_b16 v[26:27], v3 offset:57344
    v_exp_f32 v55, v55
    v_mfma_f32_32x32x16_bf16 v[120:135], v[28:31], v[40:43], v[120:135]
    v_cvt_pk_bf16_f32 v51, v54, v55
    ds_read_b64_tr_b16 v[28:29], v2 offset:59392
    v_exp_f32 v56, v56
    ds_read_b64_tr_b16 v[30:31], v3 offset:59392
    v_exp_f32 v57, v57
    v_mfma_f32_32x32x16_bf16 v[104:119], v[32:35], v[48:51], v[104:119]
    v_cvt_pk_bf16_f32 v56, v56, v57
    ds_read_b64_tr_b16 v[32:33], v2 offset:57600
    v_exp_f32 v58, v58
    ds_read_b64_tr_b16 v[34:35], v3 offset:57600
    v_exp_f32 v59, v59
    v_mfma_f32_32x32x16_bf16 v[120:135], v[36:39], v[48:51], v[120:135]
    v_cvt_pk_bf16_f32 v57, v58, v59
    ds_read_b64_tr_b16 v[36:37], v2 offset:59648
    v_exp_f32 v60, v60
    ds_read_b64_tr_b16 v[38:39], v3 offset:59648
    v_exp_f32 v61, v61
    v_add_u32 v7, 1, v7
    v_mfma_f32_32x32x16_bf16 v[40:55], v[8:11], v[88:91], 0
    v_cvt_pk_bf16_f32 v58, v60, v61
    ds_read_b128 v[8:11], v0 offset:61440
    v_exp_f32 v62, v62
    v_exp_f32 v63, v63
    v_mfma_f32_32x32x16_bf16 v[40:55], v[12:15], v[92:95], v[40:55]
    v_cvt_pk_bf16_f32 v59, v62, v63
    ds_read_b128 v[12:15], v1 offset:62464
    v_exp_f32 v64, v64
    v_exp_f32 v65, v65
    s_cmp_eq_u32 s20, 1
    s_cbranch_scc0 KF_BL5_1
    s_setprio 0
KF_BL5_1:
    v_mfma_f32_32x32x16_bf16 v[40:55], v[16:19], v[96:99], v[40:55]
    v_cvt_pk_bf16_f32 v64, v64, v65
    v_exp_f32 v66, v66
    v_exp_f32 v67, v67
    v_mfma_f32_32x32x16_bf16 v[40:55], v[20:23], v[100:103], v[40:55]
    v_cvt_pk_bf16_f32 v65, v66, v67
    ds_read_b128 v[20:23], v1 offset:64512
    v_exp_f32 v68, v68
    v_exp_f32 v69, v69
    s_waitcnt lgkmcnt(3)
    v_mfma_f32_32x32x16_bf16 v[104:119], v[24:27], v[56:59], v[104:119]
    v_cvt_pk_bf16_f32 v66, v68, v69
    v_exp_f32 v70, v70
    v_exp_f32 v71, v71
    v_mfma_f32_32x32x16_bf16 v[120:135], v[28:31], v[56:59], v[120:135]
    v_cvt_pk_bf16_f32 v67, v70, v71
    ds_read_b128 v[16:19], v0 offset:63488
    v_exp_f32 v40, v40
    v_exp_f32 v41, v41
    v_mfma_f32_32x32x16_bf16 v[104:119], v[32:35], v[64:67], v[104:119]
    v_cvt_pk_bf16_f32 v40, v40, v41
    v_exp_f32 v42, v42
    v_exp_f32 v43, v43
    v_mfma_f32_32x32x16_bf16 v[120:135], v[36:39], v[64:67], v[120:135]
    v_cvt_pk_bf16_f32 v41, v42, v43
    v_exp_f32 v44, v44
    v_exp_f32 v45, v45
    s_waitcnt lgkmcnt(0)
    v_mfma_f32_32x32x16_bf16 v[56:71], v[8:11], v[72:75], 0
    v_cvt_pk_bf16_f32 v42, v44, v45
    v_exp_f32 v46, v46
    v_exp_f32 v47, v47
    v_mfma_f32_32x32x16_bf16 v[56:71], v[12:15], v[76:79], v[56:71]
    v_cvt_pk_bf16_f32 v43, v46, v47
    v_exp_f32 v48, v48
    v_exp_f32 v49, v49
    v_mfma_f32_32x32x16_bf16 v[56:71], v[16:19], v[80:83], v[56:71]
    v_cvt_pk_bf16_f32 v48, v48, v49
    v_exp_f32 v50, v50
    v_exp_f32 v51, v51
    v_mfma_f32_32x32x16_bf16 v[56:71], v[20:23], v[84:87], v[56:71]
    v_cvt_pk_bf16_f32 v49, v50, v51
    v_exp_f32 v52, v52
    v_exp_f32 v53, v53
    v_mfma_f32_32x32x16_bf16 v[136:151], v[24:27], v[40:43], v[136:151]
    v_cvt_pk_bf16_f32 v50, v52, v53
    ds_read_b64_tr_b16 v[24:25], v2 offset:61440
    v_exp_f32 v54, v54
    ds_read_b64_tr_b16 v[26:27], v3 offset:61440
    v_exp_f32 v55, v55
    v_mfma_f32_32x32x16_bf16 v[152:167], v[28:31], v[40:43], v[152:167]
    v_cvt_pk_bf16_f32 v51, v54, v55
    ds_read_b64_tr_b16 v[28:29], v2 offset:63488
    v_exp_f32 v56, v56
    ds_read_b64_tr_b16 v[30:31], v3 offset:63488
    v_exp_f32 v57, v57
    v_mfma_f32_32x32x16_bf16 v[136:151], v[32:35], v[48:51], v[136:151]
    v_cvt_pk_bf16_f32 v56, v56, v57
    ds_read_b64_tr_b16 v[32:33], v2 offset:61696
    v_exp_f32 v58, v58
    ds_read_b64_tr_b16 v[34:35], v3 offset:61696
    v_exp_f32 v59, v59
    v_mfma_f32_32x32x16_bf16 v[152:167], v[36:39], v[48:51], v[152:167]
    v_cvt_pk_bf16_f32 v57, v58, v59
    ds_read_b64_tr_b16 v[36:37], v2 offset:63744
    v_exp_f32 v60, v60
    ds_read_b64_tr_b16 v[38:39], v3 offset:63744
    v_exp_f32 v61, v61
    v_mfma_f32_32x32x16_bf16 v[40:55], v[8:11], v[88:91], 0
    v_cvt_pk_bf16_f32 v58, v60, v61
    ds_read_b128 v[8:11], v0 offset:32768
    v_exp_f32 v62, v62
    v_exp_f32 v63, v63
    v_mfma_f32_32x32x16_bf16 v[40:55], v[12:15], v[92:95], v[40:55]
    v_cvt_pk_bf16_f32 v59, v62, v63
    ds_read_b128 v[12:15], v1 offset:33792
    v_exp_f32 v64, v64
    v_exp_f32 v65, v65
    v_mfma_f32_32x32x16_bf16 v[40:55], v[16:19], v[96:99], v[40:55]
    v_cvt_pk_bf16_f32 v64, v64, v65
    v_exp_f32 v66, v66
    v_exp_f32 v67, v67
    ds_read_b32 v60, v6
    v_mfma_f32_32x32x16_bf16 v[40:55], v[20:23], v[100:103], v[40:55]
    v_cvt_pk_bf16_f32 v65, v66, v67
    ds_read_b128 v[20:23], v1 offset:35840
    v_exp_f32 v68, v68
    v_exp_f32 v69, v69
    s_waitcnt lgkmcnt(4)
    v_mfma_f32_32x32x16_bf16 v[104:119], v[24:27], v[56:59], v[104:119]
    v_cvt_pk_bf16_f32 v66, v68, v69
    v_exp_f32 v70, v70
    v_exp_f32 v71, v71
    v_mfma_f32_32x32x16_bf16 v[120:135], v[28:31], v[56:59], v[120:135]
    v_cvt_pk_bf16_f32 v67, v70, v71
    ds_read_b128 v[16:19], v0 offset:34816
    v_exp_f32 v40, v40
    v_exp_f32 v41, v41
    v_mfma_f32_32x32x16_bf16 v[104:119], v[32:35], v[64:67], v[104:119]
    v_cvt_pk_bf16_f32 v40, v40, v41
    v_exp_f32 v42, v42
    v_exp_f32 v43, v43
    v_xor_b32 v0, 0x10000, v0
    v_mfma_f32_32x32x16_bf16 v[120:135], v[36:39], v[64:67], v[120:135]
    v_cvt_pk_bf16_f32 v41, v42, v43
    v_exp_f32 v44, v44
    v_exp_f32 v45, v45
    v_xor_b32 v1, 0x10000, v1
    s_waitcnt lgkmcnt(0)
    v_cmp_ge_u32 vcc, v7, v60
    v_mfma_f32_32x32x16_bf16 v[56:71], v[8:11], v[72:75], 0
    v_cvt_pk_bf16_f32 v42, v44, v45
    s_cbranch_vccnz KF_SPIN8_1
KF_GO8_1:
    ds_read_b128 v[8:11], v0 offset:24576
    v_exp_f32 v46, v46
    v_exp_f32 v47, v47
    v_mfma_f32_32x32x16_bf16 v[56:71], v[12:15], v[76:79], v[56:71]
    v_cvt_pk_bf16_f32 v43, v46, v47
    ds_read_b128 v[12:15], v1 offset:25600
    v_exp_f32 v48, v48
    v_exp_f32 v49, v49
    v_mfma_f32_32x32x16_bf16 v[56:71], v[16:19], v[80:83], v[56:71]
    v_cvt_pk_bf16_f32 v48, v48, v49
    ds_read_b128 v[16:19], v0 offset:26624
    v_exp_f32 v50, v50
    v_exp_f32 v51, v51
    v_mfma_f32_32x32x16_bf16 v[56:71], v[20:23], v[84:87], v[56:71]
    v_cvt_pk_bf16_f32 v49, v50, v51
    ds_read_b128 v[20:23], v1 offset:27648
    v_exp_f32 v52, v52
    v_exp_f32 v53, v53
    v_mfma_f32_32x32x16_bf16 v[136:151], v[24:27], v[40:43], v[136:151]
    v_cvt_pk_bf16_f32 v50, v52, v53
    ds_read_b64_tr_b16 v[24:25], v2 offset:32768
    v_exp_f32 v54, v54
    ds_read_b64_tr_b16 v[26:27], v3 offset:32768
    v_exp_f32 v55, v55
    v_mfma_f32_32x32x16_bf16 v[152:167], v[28:31], v[40:43], v[152:167]
    v_cvt_pk_bf16_f32 v51, v54, v55
    ds_read_b64_tr_b16 v[28:29], v2 offset:34816
    v_exp_f32 v56, v56
    ds_read_b64_tr_b16 v[30:31], v3 offset:34816
    v_exp_f32 v57, v57
    v_mfma_f32_32x32x16_bf16 v[136:151], v[32:35], v[48:51], v[136:151]
    v_cvt_pk_bf16_f32 v56, v56, v57
    ds_read_b64_tr_b16 v[32:33], v2 offset:33024
    v_exp_f32 v58, v58
    ds_read_b64_tr_b16 v[34:35], v3 offset:33024
    v_exp_f32 v59, v59
    v_mfma_f32_32x32x16_bf16 v[152:167], v[36:39], v[48:51], v[152:167]
    v_cvt_pk_bf16_f32 v57, v58, v59
    ds_read_b64_tr_b16 v[36:37], v2 offset:35072
    v_exp_f32 v60, v60
    ds_read_b64_tr_b16 v[38:39], v3 offset:35072
    v_exp_f32 v61, v61
    s_waitcnt lgkmcnt(8)
    v_mfma_f32_32x32x16_bf16 v[40:55], v[8:11], v[72:75], 0
    v_cvt_pk_bf16_f32 v58, v60, v61
    v_exp_f32 v62, v62
    v_exp_f32 v63, v63
    v_mfma_f32_32x32x16_bf16 v[40:55], v[12:15], v[76:79], v[40:55]
    v_cvt_pk_bf16_f32 v59, v62, v63
    v_exp_f32 v64, v64
    v_exp_f32 v65, v65
    v_xor_b32 v2, 0x10000, v2
    v_mfma_f32_32x32x16_bf16 v[40:55], v[16:19], v[80:83], v[40:55]
    v_cvt_pk_bf16_f32 v64, v64, v65
    v_exp_f32 v66, v66
    v_exp_f32 v67, v67
    v_xor_b32 v3, 0x10000, v3
    v_mfma_f32_32x32x16_bf16 v[40:55], v[20:23], v[84:87], v[40:55]
    v_cvt_pk_bf16_f32 v65, v66, v67
    v_exp_f32 v68, v68
    v_exp_f32 v69, v69
    s_waitcnt lgkmcnt(0)
    v_mfma_f32_32x32x16_bf16 v[104:119], v[24:27], v[56:59], v[104:119]
    v_cvt_pk_bf16_f32 v66, v68, v69
    ds_write_b32 v6, v7 offset:16
    ds_read_b64_tr_b16 v[24:25], v2 offset:24576
    v_exp_f32 v70, v70
    ds_read_b64_tr_b16 v[26:27], v3 offset:24576
    v_exp_f32 v71, v71
    v_mfma_f32_32x32x16_bf16 v[120:135], v[28:31], v[56:59], v[120:135]
    v_cvt_pk_bf16_f32 v67, v70, v71
    ds_read_b64_tr_b16 v[28:29], v2 offset:26624
    v_exp_f32 v40, v40
    ds_read_b64_tr_b16 v[30:31], v3 offset:26624
    v_exp_f32 v41, v41
    s_sub_u32 s20, s20, 1
    v_mfma_f32_32x32x16_bf16 v[104:119], v[32:35], v[64:67], v[104:119]
    v_cvt_pk_bf16_f32 v40, v40, v41
    ds_read_b64_tr_b16 v[32:33], v2 offset:24832
    v_exp_f32 v42, v42
    ds_read_b64_tr_b16 v[34:35], v3 offset:24832
    v_exp_f32 v43, v43
    s_cmp_lg_u32 s20, 0
    v_mfma_f32_32x32x16_bf16 v[120:135], v[36:39], v[64:67], v[120:135]
    v_cvt_pk_bf16_f32 v41, v42, v43
    ds_read_b64_tr_b16 v[36:37], v2 offset:26880
    v_exp_f32 v44, v44
    ds_read_b64_tr_b16 v[38:39], v3 offset:26880
    v_exp_f32 v45, v45
    v_add_u32 v7, 1, v7
    s_cbranch_scc1 KF_LOOP_1
    s_branch KF_LE
KF_V_2:
    s_waitcnt lgkmcnt(0)
    v_mfma_f32_32x32x16_bf16 v[40:55], v[8:11], v[72:75], 0
    v_cvt_pk_bf16_f32 v96, v56, v57
    v_cvt_pk_bf16_f32 v97, v58, v59
    v_mfma_f32_32x32x16_bf16 v[40:55], v[12:15], v[76:79], v[40:55]
    v_cvt_pk_bf16_f32 v98, v60, v61
    v_cvt_pk_bf16_f32 v99, v62, v63
    v_mfma_f32_32x32x16_bf16 v[40:55], v[16:19], v[80:83], v[40:55]
    v_cvt_pk_bf16_f32 v100, v64, v65
    v_cvt_pk_bf16_f32 v101, v66, v67
    v_mfma_f32_32x32x16_bf16 v[40:55], v[20:23], v[84:87], v[40:55]
    v_cvt_pk_bf16_f32 v102, v68, v69
    v_cvt_pk_bf16_f32 v103, v70, v71
    ds_read_b64_tr_b16 v[24:25], v2 offset:28672
    ds_read_b64_tr_b16 v[26:27], v3 offset:28672
    ds_read_b64_tr_b16 v[28:29], v2 offset:30720
    ds_read_b64_tr_b16 v[30:31], v3 offset:30720
    ds_read_b64_tr_b16 v[32:33], v2 offset:28928
    ds_read_b64_tr_b16 v[34:35], v3 offset:28928
    ds_read_b64_tr_b16 v[36:37], v2 offset:30976
    ds_read_b64_tr_b16 v[38:39], v3 offset:30976
    s_nop 1
    v_exp_f32 v40, v40
    v_exp_f32 v41, v41
    v_exp_f32 v42, v42
    v_exp_f32 v43, v43
    v_exp_f32 v44, v44
    v_exp_f32 v45, v45
    v_cvt_pk_bf16_f32 v40, v40, v41
    v_cvt_pk_bf16_f32 v41, v42, v43
.p2align 6
KF_LOOP_2:
    v_mfma_f32_32x32x16_bf16 v[56:71], v[8:11], v[88:91], 0
    v_cvt_pk_bf16_f32 v42, v44, v45
    ds_read_b128 v[8:11], v0 offset:0
    v_exp_f32 v46, v46
    v_exp_f32 v47, v47
    v_mfma_f32_32x32x16_bf16 v[56:71], v[12:15], v[92:95], v[56:71]
    v_cvt_pk_bf16_f32 v43, v46, v47
    ds_read_b128 v[12:15], v1 offset:1024
    v_exp_f32 v48, v48
    v_exp_f32 v49, v49
    s_cmp_eq_u32 s20, 2
    s_cbranch_scc0 KF_BL0_2
    s_setprio 1
KF_BL0_2:
    v_mfma_f32_32x32x16_bf16 v[56:71], v[16:19], v[96:99], v[56:71]
    v_cvt_pk_bf16_f32 v48, v48, v49
    v_exp_f32 v50, v50
    v_exp_f32 v51, v51
    v_mfma_f32_32x32x16_bf16 v[56:71], v[20:23], v[100:103], v[56:71]
    v_cvt_pk_bf16_f32 v49, v50, v51
    ds_read_b128 v[20:23], v1 offset:3072
    v_exp_f32 v52, v52
    v_exp_f32 v53, v53
    s_waitcnt lgkmcnt(3)
    v_mfma_f32_32x32x16_bf16 v[104:119], v[24:27], v[40:43], v[104:119]
    v_cvt_pk_bf16_f32 v50, v52, v53
    v_exp_f32 v54, v54
    v_exp_f32 v55, v55
    v_mfma_f32_32x32x16_bf16 v[120:135], v[28:31], v[40:43], v[120:135]
    v_cvt_pk_bf16_f32 v51, v54, v55
    ds_read_b128 v[16:19], v0 offset:2048
    v_exp_f32 v56, v56
    v_exp_f32 v57, v57
    v_mfma_f32_32x32x16_bf16 v[104:119], v[32:35], v[48:51], v[104:119]
    v_cvt_pk_bf16_f32 v56, v56, v57
    v_exp_f32 v58, v58
    v_exp_f32 v59, v59
    v_mfma_f32_32x32x16_bf16 v[120:135], v[36:39], v[48:51], v[120:135]
    v_cvt_pk_bf16_f32 v57, v58, v59
    v_exp_f32 v60, v60
    v_exp_f32 v61, v61
    s_waitcnt lgkmcnt(0)
    v_mfma_f32_32x32x16_bf16 v[40:55], v[8:11], v[72:75], 0
    v_cvt_pk_bf16_f32 v58, v60, v61
    v_exp_f32 v62, v62
    v_exp_f32 v63, v63
    v_mfma_f32_32x32x16_bf16 v[40:55], v[12:15], v[76:79], v[40:55]
    v_cvt_pk_bf16_f32 v59, v62, v63
    v_exp_f32 v64, v64
    v_exp_f32 v65, v65
    v_mfma_f32_32x32x16_bf16 v[40:55], v[16:19], v[80:83], v[40:55]
    v_cvt_pk_bf16_f32 v64, v64, v65
    v_exp_f32 v66, v66
    v_exp_f32 v67, v67
    v_mfma_f32_32x32x16_bf16 v[40:55], v[20:23], v[84:87], v[40:55]
    v_cvt_pk_bf16_f32 v65, v66, v67
    v_exp_f32 v68, v68
    v_exp_f32 v69, v69
    v_mfma_f32_32x32x16_bf16 v[136:151], v[24:27], v[56:59], v[136:151]
    v_cvt_pk_bf16_f32 v66, v68, v69
    ds_read_b64_tr_b16 v[24:25], v2 offset:0
    v_exp_f32 v70, v70
    ds_read_b64_tr_b16 v[26:27], v3 offset:0
    v_exp_f32 v71, v71
    v_mfma_f32_32x32x16_bf16 v[152:167], v[28:31], v[56:59], v[152:167]
    v_cvt_pk_bf16_f32 v67, v70, v71
    ds_read_b64_tr_b16 v[28:29], v2 offset:2048
    v_exp_f32 v40, v40
    ds_read_b64_tr_b16 v[30:31], v3 offset:2048
    v_exp_f32 v41, v41
    v_mfma_f32_32x32x16_bf16 v[136:151], v[32:35], v[64:67], v[136:151]
    v_cvt_pk_bf16_f32 v40, v40, v41
    ds_read_b64_tr_b16 v[32:33], v2 offset:256
    v_exp_f32 v42, v42
    ds_read_b64_tr_b16 v[34:35], v3 offset:256
    v_exp_f32 v43, v43
    v_mfma_f32_32x32x16_bf16 v[152:167], v[36:39], v[64:67], v[152:167]
    v_cvt_pk_bf16_f32 v41, v42, v43
    ds_read_b64_tr_b16 v[36:37], v2 offset:2304
    v_exp_f32 v44, v44
    ds_read_b64_tr_b16 v[38:39], v3 offset:2304
    v_exp_f32 v45, v45
    v_mfma_f32_32x32x16_bf16 v[56:71], v[8:11], v[88:91], 0
    v_cvt_pk_bf16_f32 v42, v44, v45
    ds_read_b128 v[8:11], v0 offset:4096
    v_exp_f32 v46, v46
    v_exp_f32 v47, v47
    v_mfma_f32_32x32x16_bf16 v[56:71], v[12:15], v[92:95], v[56:71]
    v_cvt_pk_bf16_f32 v43, v46, v47
    ds_read_b128 v[12:15], v1 offset:5120
    v_exp_f32 v48, v48
    v_exp_f32 v49, v49
    v_mfma_f32_32x32x16_bf16 v[56:71], v[16:19], v[96:99], v[56:71]
    v_cvt_pk_bf16_f32 v48, v48, v49
    v_exp_f32 v50, v50
    v_exp_f32 v51, v51
    ds_read_b32 v44, v6
    v_mfma_f32_32x32x16_bf16 v[56:71], v[20:23], v[100:103], v[56:71]
    v_cvt_pk_bf16_f32 v49, v50, v51
    ds_read_b128 v[20:23], v1 offset:7168
    v_exp_f32 v52, v52
    v_exp_f32 v53, v53
    s_waitcnt lgkmcnt(4)
    v_mfma_f32_32x32x16_bf16 v[104:119], v[24:27], v[40:43], v[104:119]
    v_cvt_pk_bf16_f32 v50, v52, v53
    v_exp_f32 v54, v54
    v_exp_f32 v55, v55
    v_mfma_f32_32x32x16_bf16 v[120:135], v[28:31], v[40:43], v[120:135]
    v_cvt_pk_bf16_f32 v51, v54, v55
    ds_read_b128 v[16:19], v0 offset:6144
    v_exp_f32 v56, v56
    v_exp_f32 v57, v57
    v_mfma_f32_32x32x16_bf16 v[104:119], v[32:35], v[48:51], v[104:119]
    v_cvt_pk_bf16_f32 v56, v56, v57
    v_exp_f32 v58, v58
    v_exp_f32 v59, v59
    v_mfma_f32_32x32x16_bf16 v[120:135], v[36:39], v[48:51], v[120:135]
    v_cvt_pk_bf16_f32 v57, v58, v59
    v_exp_f32 v60, v60
    v_exp_f32 v61, v61
    s_waitcnt lgkmcnt(0)
    v_cmp_ge_u32 vcc, v7, v44
    v_mfma_f32_32x32x16_bf16 v[40:55], v[8:11], v[72:75], 0
    v_cvt_pk_bf16_f32 v58, v60, v61
    s_cbranch_vccnz KF_SPIN3_2
KF_GO3_2:
    ds_read_b128 v[8:11], v0 offset:61440
    v_exp_f32 v62, v62
    v_exp_f32 v63, v63
    v_mfma_f32_32x32x16_bf16 v[40:55], v[12:15], v[76:79], v[40:55]
    v_cvt_pk_bf16_f32 v59, v62, v63
    ds_read_b128 v[12:15], v1 offset:62464
    v_exp_f32 v64, v64
    v_exp_f32 v65, v65
    v_mfma_f32_32x32x16_bf16 v[40:55], v[16:19], v[80:83], v[40:55]
    v_cvt_pk_bf16_f32 v64, v64, v65
    ds_read_b128 v[16:19], v0 offset:63488
    v_exp_f32 v66, v66
    v_exp_f32 v67, v67
    v_mfma_f32_32x32x16_bf16 v[40:55], v[20:23], v[84:87], v[40:55]
    v_cvt_pk_bf16_f32 v65, v66, v67
    ds_read_b128 v[20:23], v1 offset:64512
    v_exp_f32 v68, v68
    v_exp_f32 v69, v69
    v_mfma_f32_32x32x16_bf16 v[136:151], v[24:27], v[56:59], v[136:151]
    v_cvt_pk_bf16_f32 v66, v68, v69
    ds_read_b64_tr_b16 v[24:25], v2 offset:4096
    v_exp_f32 v70, v70
    ds_read_b64_tr_b16 v[26:27], v3 offset:4096
    v_exp_f32 v71, v71
    v_mfma_f32_32x32x16_bf16 v[152:167], v[28:31], v[56:59], v[152:167]
    v_cvt_pk_bf16_f32 v67, v70, v71
    ds_read_b64_tr_b16 v[28:29], v2 offset:6144
    v_exp_f32 v40, v40
    ds_read_b64_tr_b16 v[30:31], v3 offset:6144
    v_exp_f32 v41, v41
    v_mfma_f32_32x32x16_bf16 v[136:151], v[32:35], v[64:67], v[136:151]
    v_cvt_pk_bf16_f32 v40, v40, v41
    ds_read_b64_tr_b16 v[32:33], v2 offset:4352
    v_exp_f32 v42, v42
    ds_read_b64_tr_b16 v[34:35], v3 offset:4352
    v_exp_f32 v43, v43
    v_mfma_f32_32x32x16_bf16 v[152:167], v[36:39], v[64:67], v[152:167]
    v_cvt_pk_bf16_f32 v41, v42, v43
    ds_read_b64_tr_b16 v[36:37], v2 offset:6400
    v_exp_f32 v44, v44
    ds_read_b64_tr_b16 v[38:39], v3 offset:6400
    v_exp_f32 v45, v45
    s_waitcnt lgkmcnt(8)
    v_mfma_f32_32x32x16_bf16 v[56:71], v[8:11], v[72:75], 0
    v_cvt_pk_bf16_f32 v42, v44, v45
    v_exp_f32 v46, v46
    v_exp_f32 v47, v47
    v_mfma_f32_32x32x16_bf16 v[56:71], v[12:15], v[76:79], v[56:71]
    v_cvt_pk_bf16_f32 v43, v46, v47
    v_exp_f32 v48, v48
    v_exp_f32 v49, v49
    v_mfma_f32_32x32x16_bf16 v[56:71], v[16:19], v[80:83], v[56:71]
    v_cvt_pk_bf16_f32 v48, v48, v49
    v_exp_f32 v50, v50
    v_exp_f32 v51, v51
    v_mfma_f32_32x32x16_bf16 v[56:71], v[20:23], v[84:87], v[56:71]
    v_cvt_pk_bf16_f32 v49, v50, v51
    v_exp_f32 v52, v52
    v_exp_f32 v53, v53
    s_waitcnt lgkmcnt(0)
    v_mfma_f32_32x32x16_bf16 v[104:119], v[24:27], v[40:43], v[104:119]
    v_cvt_pk_bf16_f32 v50, v52, v53
    ds_write_b32 v6, v7 offset:16
    ds_read_b64_tr_b16 v[24:25], v2 offset:61440
    v_exp_f32 v54, v54
    ds_read_b64_tr_b16 v[26:27], v3 offset:61440
    v_exp_f32 v55, v55
    v_mfma_f32_32x32x16_bf16 v[120:135], v[28:31], v[40:43], v[120:135]
    v_cvt_pk_bf16_f32 v51, v54, v55
    ds_read_b64_tr_b16 v[28:29], v2 offset:63488
    v_exp_f32 v56, v56
    ds_read_b64_tr_b16 v[30:31], v3 offset:63488
    v_exp_f32 v57, v57
    v_mfma_f32_32x32x16_bf16 v[104:119], v[32:35], v[48:51], v[104:119]
    v_cvt_pk_bf16_f32 v56, v56, v57
    ds_read_b64_tr_b16 v[32:33], v2 offset:61696
    v_exp_f32 v58, v58
    ds_read_b64_tr_b16 v[34:35], v3 offset:61696
    v_exp_f32 v59, v59
    v_mfma_f32_32x32x16_bf16 v[120:135], v[36:39], v[48:51], v[120:135]
    v_cvt_pk_bf16_f32 v57, v58, v59
    ds_read_b64_tr_b16 v[36:37], v2 offset:63744
    v_exp_f32 v60, v60
    ds_read_b64_tr_b16 v[38:39], v3 offset:63744
    v_exp_f32 v61, v61
    v_add_u32 v7, 1, v7
    v_mfma_f32_32x32x16_bf16 v[40:55], v[8:11], v[88:91], 0
    v_cvt_pk_bf16_f32 v58, v60, v61
    ds_read_b128 v[8:11], v0 offset:32768
    v_exp_f32 v62, v62
    v_exp_f32 v63, v63
    v_mfma_f32_32x32x16_bf16 v[40:55], v[12:15], v[92:95], v[40:55]
    v_cvt_pk_bf16_f32 v59, v62, v63
    ds_read_b128 v[12:15], v1 offset:33792
    v_exp_f32 v64, v64
    v_exp_f32 v65, v65
    s_cmp_eq_u32 s20, 1
    s_cbranch_scc0 KF_BL5_2
    s_setprio 0
KF_BL5_2:
    v_mfma_f32_32x32x16_bf16 v[40:55], v[16:19], v[96:99], v[40:55]
    v_cvt_pk_bf16_f32 v64, v64, v65
    v_exp_f32 v66, v66
    v_exp_f32 v67, v67
    v_mfma_f32_32x32x16_bf16 v[40:55], v[20:23], v[100:103], v[40:55]
    v_cvt_pk_bf16_f32 v65, v66, v67
    ds_read_b128 v[20:23], v1 offset:35840
    v_exp_f32 v68, v68
    v_exp_f32 v69, v69
    s_waitcnt lgkmcnt(3)
    v_mfma_f32_32x32x16_bf16 v[104:119], v[24:27], v[56:59], v[104:119]
    v_cvt_pk_bf16_f32 v66, v68, v69
    v_exp_f32 v70, v70
    v_exp_f32 v71, v71
    v_mfma_f32_32x32x16_bf16 v[120:135], v[28:31], v[56:59], v[120:135]
    v_cvt_pk_bf16_f32 v67, v70, v71
    ds_read_b128 v[16:19], v0 offset:34816
    v_exp_f32 v40, v40
    v_exp_f32 v41, v41
    v_mfma_f32_32x32x16_bf16 v[104:119], v[32:35], v[64:67], v[104:119]
    v_cvt_pk_bf16_f32 v40, v40, v41
    v_exp_f32 v42, v42
    v_exp_f32 v43, v43
    v_mfma_f32_32x32x16_bf16 v[120:135], v[36:39], v[64:67], v[120:135]
    v_cvt_pk_bf16_f32 v41, v42, v43
    v_exp_f32 v44, v44
    v_exp_f32 v45, v45
    s_waitcnt lgkmcnt(0)
    v_mfma_f32_32x32x16_bf16 v[56:71], v[8:11], v[72:75], 0
    v_cvt_pk_bf16_f32 v42, v44, v45
    v_exp_f32 v46, v46
    v_exp_f32 v47, v47
    v_mfma_f32_32x32x16_bf16 v[56:71], v[12:15], v[76:79], v[56:71]
    v_cvt_pk_bf16_f32 v43, v46, v47
    v_exp_f32 v48, v48
    v_exp_f32 v49, v49
    v_mfma_f32_32x32x16_bf16 v[56:71], v[16:19], v[80:83], v[56:71]
    v_cvt_pk_bf16_f32 v48, v48, v49
    v_exp_f32 v50, v50
    v_exp_f32 v51, v51
    v_mfma_f32_32x32x16_bf16 v[56:71], v[20:23], v[84:87], v[56:71]
    v_cvt_pk_bf16_f32 v49, v50, v51
    v_exp_f32 v52, v52
    v_exp_f32 v53, v53
    v_mfma_f32_32x32x16_bf16 v[136:151], v[24:27], v[40:43], v[136:151]
    v_cvt_pk_bf16_f32 v50, v52, v53
    ds_read_b64_tr_b16 v[24:25], v2 offset:32768
    v_exp_f32 v54, v54
    ds_read_b64_tr_b16 v[26:27], v3 offset:32768
    v_exp_f32 v55, v55
    v_mfma_f32_32x32x16_bf16 v[152:167], v[28:31], v[40:43], v[152:167]
    v_cvt_pk_bf16_f32 v51, v54, v55
    ds_read_b64_tr_b16 v[28:29], v2 offset:34816
    v_exp_f32 v56, v56
    ds_read_b64_tr_b16 v[30:31], v3 offset:34816
    v_exp_f32 v57, v57
    v_mfma_f32_32x32x16_bf16 v[136:151], v[32:35], v[48:51], v[136:151]
    v_cvt_pk_bf16_f32 v56, v56, v57
    ds_read_b64_tr_b16 v[32:33], v2 offset:33024
    v_exp_f32 v58, v58
    ds_read_b64_tr_b16 v[34:35], v3 offset:33024
    v_exp_f32 v59, v59
    v_mfma_f32_32x32x16_bf16 v[152:167], v[36:39], v[48:51], v[152:167]
    v_cvt_pk_bf16_f32 v57, v58, v59
    ds_read_b64_tr_b16 v[36:37], v2 offset:35072
    v_exp_f32 v60, v60
    ds_read_b64_tr_b16 v[38:39], v3 offset:35072
    v_exp_f32 v61, v61
    v_mfma_f32_32x32x16_bf16 v[40:55], v[8:11], v[88:91], 0
    v_cvt_pk_bf16_f32 v58, v60, v61
    ds_read_b128 v[8:11], v0 offset:36864
    v_exp_f32 v62, v62
    v_exp_f32 v63, v63
    v_mfma_f32_32x32x16_bf16 v[40:55], v[12:15], v[92:95], v[40:55]
    v_cvt_pk_bf16_f32 v59, v62, v63
    ds_read_b128 v[12:15], v1 offset:37888
    v_exp_f32 v64, v64
    v_exp_f32 v65, v65
    v_mfma_f32_32x32x16_bf16 v[40:55], v[16:19], v[96:99], v[40:55]
    v_cvt_pk_bf16_f32 v64, v64, v65
    v_exp_f32 v66, v66
    v_exp_f32 v67, v67
    ds_read_b32 v60, v6
    v_mfma_f32_32x32x16_bf16 v[40:55], v[20:23], v[100:103], v[40:55]
    v_cvt_pk_bf16_f32 v65, v66, v67
    ds_read_b128 v[20:23], v1 offset:39936
    v_exp_f32 v68, v68
    v_exp_f32 v69, v69
    s_waitcnt lgkmcnt(4)
    v_mfma_f32_32x32x16_bf16 v[104:119], v[24:27], v[56:59], v[104:119]
    v_cvt_pk_bf16_f32 v66, v68, v69
    v_exp_f32 v70, v70
    v_exp_f32 v71, v71
    v_mfma_f32_32x32x16_bf16 v[120:135], v[28:31], v[56:59], v[120:135]
    v_cvt_pk_bf16_f32 v67, v70, v71
    ds_read_b128 v[16:19], v0 offset:38912
    v_exp_f32 v40, v40
    v_exp_f32 v41, v41
    v_mfma_f32_32x32x16_bf16 v[104:119], v[32:35], v[64:67], v[104:119]
    v_cvt_pk_bf16_f32 v40, v40, v41
    v_exp_f32 v42, v42
    v_exp_f32 v43, v43
    v_xor_b32 v0, 0x10000, v0
    v_mfma_f32_32x32x16_bf16 v[120:135], v[36:39], v[64:67], v[120:135]
    v_cvt_pk_bf16_f32 v41, v42, v43
    v_exp_f32 v44, v44
    v_exp_f32 v45, v45
    v_xor_b32 v1, 0x10000, v1
    s_waitcnt lgkmcnt(0)
    v_cmp_ge_u32 vcc, v7, v60
    v_mfma_f32_32x32x16_bf16 v[56:71], v[8:11], v[72:75], 0
    v_cvt_pk_bf16_f32 v42, v44, v45
    s_cbranch_vccnz KF_SPIN8_2
KF_GO8_2:
    ds_read_b128 v[8:11], v0 offset:28672
    v_exp_f32 v46, v46
    v_exp_f32 v47, v47
    v_mfma_f32_32x32x16_bf16 v[56:71], v[12:15], v[76:79], v[56:71]
    v_cvt_pk_bf16_f32 v43, v46, v47
    ds_read_b128 v[12:15], v1 offset:29696
    v_exp_f32 v48, v48
    v_exp_f32 v49, v49
    v_mfma_f32_32x32x16_bf16 v[56:71], v[16:19], v[80:83], v[56:71]
    v_cvt_pk_bf16_f32 v48, v48, v49
    ds_read_b128 v[16:19], v0 offset:30720
    v_exp_f32 v50, v50
    v_exp_f32 v51, v51
    v_mfma_f32_32x32x16_bf16 v[56:71], v[20:23], v[84:87], v[56:71]
    v_cvt_pk_bf16_f32 v49, v50, v51
    ds_read_b128 v[20:23], v1 offset:31744
    v_exp_f32 v52, v52
    v_exp_f32 v53, v53
    v_mfma_f32_32x32x16_bf16 v[136:151], v[24:27], v[40:43], v[136:151]
    v_cvt_pk_bf16_f32 v50, v52, v53
    ds_read_b64_tr_b16 v[24:25], v2 offset:36864
    v_exp_f32 v54, v54
    ds_read_b64_tr_b16 v[26:27], v3 offset:36864
    v_exp_f32 v55, v55
    v_mfma_f32_32x32x16_bf16 v[152:167], v[28:31], v[40:43], v[152:167]
    v_cvt_pk_bf16_f32 v51, v54, v55
    ds_read_b64_tr_b16 v[28:29], v2 offset:38912
    v_exp_f32 v56, v56
    ds_read_b64_tr_b16 v[30:31], v3 offset:38912
    v_exp_f32 v57, v57
    v_mfma_f32_32x32x16_bf16 v[136:151], v[32:35], v[48:51], v[136:151]
    v_cvt_pk_bf16_f32 v56, v56, v57
    ds_read_b64_tr_b16 v[32:33], v2 offset:37120
    v_exp_f32 v58, v58
    ds_read_b64_tr_b16 v[34:35], v3 offset:37120
    v_exp_f32 v59, v59
    v_mfma_f32_32x32x16_bf16 v[152:167], v[36:39], v[48:51], v[152:167]
    v_cvt_pk_bf16_f32 v57, v58, v59
    ds_read_b64_tr_b16 v[36:37], v2 offset:39168
    v_exp_f32 v60, v60
    ds_read_b64_tr_b16 v[38:39], v3 offset:39168
    v_exp_f32 v61, v61
    s_waitcnt lgkmcnt(8)
    v_mfma_f32_32x32x16_bf16 v[40:55], v[8:11], v[72:75], 0
    v_cvt_pk_bf16_f32 v58, v60, v61
    v_exp_f32 v62, v62
    v_exp_f32 v63, v63
    v_mfma_f32_32x32x16_bf16 v[40:55], v[12:15], v[76:79], v[40:55]
    v_cvt_pk_bf16_f32 v59, v62, v63
    v_exp_f32 v64, v64
    v_exp_f32 v65, v65
    v_xor_b32 v2, 0x10000, v2
    v_mfma_f32_32x32x16_bf16 v[40:55], v[16:19], v[80:83], v[40:55]
    v_cvt_pk_bf16_f32 v64, v64, v65
    v_exp_f32 v66, v66
    v_exp_f32 v67, v67
    v_xor_b32 v3, 0x10000, v3
    v_mfma_f32_32x32x16_bf16 v[40:55], v[20:23], v[84:87], v[40:55]
    v_cvt_pk_bf16_f32 v65, v66, v67
    v_exp_f32 v68, v68
    v_exp_f32 v69, v69
    s_waitcnt lgkmcnt(0)
    v_mfma_f32_32x32x16_bf16 v[104:119], v[24:27], v[56:59], v[104:119]
    v_cvt_pk_bf16_f32 v66, v68, v69
    ds_write_b32 v6, v7 offset:16
    ds_read_b64_tr_b16 v[24:25], v2 offset:28672
    v_exp_f32 v70, v70
    ds_read_b64_tr_b16 v[26:27], v3 offset:28672
    v_exp_f32 v71, v71
    v_mfma_f32_32x32x16_bf16 v[120:135], v[28:31], v[56:59], v[120:135]
    v_cvt_pk_bf16_f32 v67, v70, v71
    ds_read_b64_tr_b16 v[28:29], v2 offset:30720
    v_exp_f32 v40, v40
    ds_read_b64_tr_b16 v[30:31], v3 offset:30720
    v_exp_f32 v41, v41
    s_sub_u32 s20, s20, 1
    v_mfma_f32_32x32x16_bf16 v[104:119], v[32:35], v[64:67], v[104:119]
    v_cvt_pk_bf16_f32 v40, v40, v41
    ds_read_b64_tr_b16 v[32:33], v2 offset:28928
    v_exp_f32 v42, v42
    ds_read_b64_tr_b16 v[34:35], v3 offset:28928
    v_exp_f32 v43, v43
    s_cmp_lg_u32 s20, 0
    v_mfma_f32_32x32x16_bf16 v[120:135], v[36:39], v[64:67], v[120:135]
    v_cvt_pk_bf16_f32 v41, v42, v43
    ds_read_b64_tr_b16 v[36:37], v2 offset:30976
    v_exp_f32 v44, v44
    ds_read_b64_tr_b16 v[38:39], v3 offset:30976
    v_exp_f32 v45, v45
    v_add_u32 v7, 1, v7
    s_cbranch_scc1 KF_LOOP_2
KF_LE:
    s_cmp_eq_u32 s14, 0
    s_cbranch_scc1 KF_EO
    s_setprio 2
KF_EPW:
    ds_read_b32 v0, v5
    v_add_u32 v1, 98304, v4
    s_waitcnt lgkmcnt(0)
    v_cmp_gt_u32 vcc, 9, v0
    s_cbranch_vccz KF_EPG
    s_sleep 1
    s_branch KF_EPW
KF_EPG:
    ds_write_b128 v4, v[136:139] offset:0
    ds_write_b128 v4, v[140:143] offset:1024
    ds_write_b128 v4, v[144:147] offset:2048
    ds_write_b128 v4, v[148:151] offset:3072
    ds_write_b128 v4, v[152:155] offset:4096
    ds_write_b128 v4, v[156:159] offset:5120
    ds_write_b128 v4, v[160:163] offset:6144
    ds_write_b128 v4, v[164:167] offset:7168
    ds_read_b128 v[8:11], v1 offset:0
    ds_read_b128 v[12:15], v1 offset:1024
    ds_read_b128 v[16:19], v1 offset:2048
    ds_read_b128 v[20:23], v1 offset:3072
    ds_read_b128 v[24:27], v1 offset:4096
    ds_read_b128 v[28:31], v1 offset:5120
    ds_read_b128 v[32:35], v1 offset:6144
    v_and_b32 v0, 1023, v4
    s_waitcnt lgkmcnt(7)
    ds_read_b128 v[36:39], v1 offset:7168
    s_barrier
    s_waitcnt lgkmcnt(7)
    v_pk_add_f32 v[104:105], v[104:105], v[8:9]
    v_pk_add_f32 v[106:107], v[106:107], v[10:11]
    v_cvt_pk_bf16_f32 v40, v104, v105
    v_cvt_pk_bf16_f32 v41, v106, v107
    v_min_u32 v40, -2, v40
    v_min_u32 v41, -2, v41
    s_waitcnt lgkmcnt(6)
    v_pk_add_f32 v[108:109], v[108:109], v[12:13]
    v_pk_add_f32 v[110:111], v[110:111], v[14:15]
    v_cvt_pk_bf16_f32 v42, v108, v109
    v_cvt_pk_bf16_f32 v43, v110, v111
    v_min_u32 v42, -2, v42
    v_min_u32 v43, -2, v43
    global_store_dwordx4 v0, v[40:43], s[28:29] offset:0 sc1
    s_waitcnt lgkmcnt(5)
    v_pk_add_f32 v[112:113], v[112:113], v[16:17]
    v_pk_add_f32 v[114:115], v[114:115], v[18:19]
    v_cvt_pk_bf16_f32 v44, v112, v113
    v_cvt_pk_bf16_f32 v45, v114, v115
    v_min_u32 v44, -2, v44
    v_min_u32 v45, -2, v45
    s_waitcnt lgkmcnt(4)
    v_pk_add_f32 v[116:117], v[116:117], v[20:21]
    v_pk_add_f32 v[118:119], v[118:119], v[22:23]
    v_cvt_pk_bf16_f32 v46, v116, v117
    v_cvt_pk_bf16_f32 v47, v118, v119
    v_min_u32 v46, -2, v46
    v_min_u32 v47, -2, v47
    global_store_dwordx4 v0, v[44:47], s[28:29] offset:1024 sc1
    s_waitcnt lgkmcnt(3)
    v_pk_add_f32 v[120:121], v[120:121], v[24:25]
    v_pk_add_f32 v[122:123], v[122:123], v[26:27]
    v_cvt_pk_bf16_f32 v48, v120, v121
    v_cvt_pk_bf16_f32 v49, v122, v123
    v_min_u32 v48, -2, v48
    v_min_u32 v49, -2, v49
    s_waitcnt lgkmcnt(2)
    v_pk_add_f32 v[124:125], v[124:125], v[28:29]
    v_pk_add_f32 v[126:127], v[126:127], v[30:31]
    v_cvt_pk_bf16_f32 v50, v124, v125
    v_cvt_pk_bf16_f32 v51, v126, v127
    v_min_u32 v50, -2, v50
    v_min_u32 v51, -2, v51
    global_store_dwordx4 v0, v[48:51], s[28:29] offset:2048 sc1
    s_waitcnt lgkmcnt(1)
    v_pk_add_f32 v[128:129], v[128:129], v[32:33]
    v_pk_add_f32 v[130:131], v[130:131], v[34:35]
    v_cvt_pk_bf16_f32 v52, v128, v129
    v_cvt_pk_bf16_f32 v53, v130, v131
    v_min_u32 v52, -2, v52
    v_min_u32 v53, -2, v53
    s_waitcnt lgkmcnt(0)
    v_pk_add_f32 v[132:133], v[132:133], v[36:37]
    v_pk_add_f32 v[134:135], v[134:135], v[38:39]
    v_cvt_pk_bf16_f32 v54, v132, v133
    v_cvt_pk_bf16_f32 v55, v134, v135
    v_min_u32 v54, -2, v54
    v_min_u32 v55, -2, v55
    global_store_dwordx4 v0, v[52:55], s[28:29] offset:3072 sc1
    s_branch KF_EQ
KF_EO:
    s_setprio 0
    v_add_u32 v1, 65536, v4
    v_and_b32 v0, 1023, v4
    s_sub_u32 s16, s9, 1
    s_and_b32 s16, s16, 3
    s_lshl_b32 s17, s16, 13
    s_add_u32 s17, s17, 65536
    v_add_u32 v2, s17, v0
    s_lshl_b32 s16, s16, 2
    s_add_u32 s16, s16, 132432
    v_mov_b32 v3, s16
    s_lshl_b32 s16, s9, 2
    s_add_u32 s16, s16, 132432
    v_mov_b32 v6, s16
    s_waitcnt lgkmcnt(0)
KF_EW1:
    ds_read_b32 v8, v5
    s_waitcnt lgkmcnt(0)
    v_cmp_gt_u32 vcc, 8, v8
    s_cmp_eq_u32 vcc_lo, 0
    s_cbranch_scc1 KF_EG1
    s_sleep 2
    s_branch KF_EW1
KF_EG1:
    ds_write_b128 v1, v[136:139] offset:0
    ds_write_b128 v1, v[140:143] offset:1024
    ds_write_b128 v1, v[144:147] offset:2048
    ds_write_b128 v1, v[148:151] offset:3072
    ds_write_b128 v1, v[152:155] offset:4096
    ds_write_b128 v1, v[156:159] offset:5120
    ds_write_b128 v1, v[160:163] offset:6144
    ds_write_b128 v1, v[164:167] offset:7168
    s_waitcnt lgkmcnt(0)
    ds_write_b32 v6, v7
KF_EW2:
    ds_read_b32 v8, v3
    s_waitcnt lgkmcnt(0)
    v_cmp_eq_u32 vcc, 0, v8
    s_cbranch_vccz KF_EG2
    s_sleep 2
    s_branch KF_EW2
KF_EG2:
    ds_read_b128 v[8:11], v2 offset:0
    ds_read_b128 v[12:15], v2 offset:1024
    ds_read_b128 v[16:19], v2 offset:2048
    ds_read_b128 v[20:23], v2 offset:3072
    ds_read_b128 v[24:27], v2 offset:4096
    ds_read_b128 v[28:31], v2 offset:5120
    ds_read_b128 v[32:35], v2 offset:6144
    ds_read_b128 v[36:39], v2 offset:7168
    s_waitcnt lgkmcnt(7)
    v_pk_add_f32 v[104:105], v[104:105], v[8:9]
    v_pk_add_f32 v[106:107], v[106:107], v[10:11]
    ds_write_b128 v1, v[104:107] offset:32768
    s_waitcnt lgkmcnt(7)
    v_pk_add_f32 v[108:109], v[108:109], v[12:13]
    v_pk_add_f32 v[110:111], v[110:111], v[14:15]
    ds_write_b128 v1, v[108:111] offset:33792
    s_waitcnt lgkmcnt(7)
    v_pk_add_f32 v[112:113], v[112:113], v[16:17]
    v_pk_add_f32 v[114:115], v[114:115], v[18:19]
    ds_write_b128 v1, v[112:115] offset:34816
    s_waitcnt lgkmcnt(7)
    v_pk_add_f32 v[116:117], v[116:117], v[20:21]
    v_pk_add_f32 v[118:119], v[118:119], v[22:23]
    ds_write_b128 v1, v[116:119] offset:35840
    s_waitcnt lgkmcnt(7)
    v_pk_add_f32 v[120:121], v[120:121], v[24:25]
    v_pk_add_f32 v[122:123], v[122:123], v[26:27]
    ds_write_b128 v1, v[120:123] offset:36864
    s_waitcnt lgkmcnt(7)
    v_pk_add_f32 v[124:125], v[124:125], v[28:29]
    v_pk_add_f32 v[126:127], v[126:127], v[30:31]
    ds_write_b128 v1, v[124:127] offset:37888
    s_waitcnt lgkmcnt(7)
    v_pk_add_f32 v[128:129], v[128:129], v[32:33]
    v_pk_add_f32 v[130:131], v[130:131], v[34:35]
    ds_write_b128 v1, v[128:131] offset:38912
    s_waitcnt lgkmcnt(7)
    v_pk_add_f32 v[132:133], v[132:133], v[36:37]
    v_pk_add_f32 v[134:135], v[134:135], v[38:39]
    ds_write_b128 v1, v[132:135] offset:39936
    s_lshl_b32 s16, s9, 11
    v_add_u32 v2, s16, v0
    s_waitcnt lgkmcnt(0)
    ds_write_b32 v6, v7 offset:16
    s_setprio 2
    s_waitcnt lgkmcnt(0)
    s_barrier
    ds_read_b128 v[8:11], v2 offset:0
    ds_read_b128 v[12:15], v2 offset:1024
    ds_read_b128 v[16:19], v2 offset:8192
    ds_read_b128 v[20:23], v2 offset:9216
    ds_read_b128 v[24:27], v2 offset:16384
    ds_read_b128 v[28:31], v2 offset:17408
    ds_read_b128 v[32:35], v2 offset:24576
    ds_read_b128 v[36:39], v2 offset:25600
    s_waitcnt lgkmcnt(4)
    v_pk_add_f32 v[8:9], v[8:9], v[16:17]
    v_pk_add_f32 v[10:11], v[10:11], v[18:19]
    v_pk_add_f32 v[12:13], v[12:13], v[20:21]
    v_pk_add_f32 v[14:15], v[14:15], v[22:23]
    s_waitcnt lgkmcnt(0)
    v_pk_add_f32 v[24:25], v[24:25], v[32:33]
    v_pk_add_f32 v[26:27], v[26:27], v[34:35]
    v_pk_add_f32 v[28:29], v[28:29], v[36:37]
    v_pk_add_f32 v[30:31], v[30:31], v[38:39]
    v_pk_add_f32 v[8:9], v[8:9], v[24:25]
    v_pk_add_f32 v[10:11], v[10:11], v[26:27]
    v_pk_add_f32 v[12:13], v[12:13], v[28:29]
    v_pk_add_f32 v[14:15], v[14:15], v[30:31]
    v_cvt_pk_bf16_f32 v8, v8, v9
    v_cvt_pk_bf16_f32 v9, v10, v11
    v_cvt_pk_bf16_f32 v10, v12, v13
    v_cvt_pk_bf16_f32 v11, v14, v15
    v_min_u32 v8, -2, v8
    v_min_u32 v9, -2, v9
    v_min_u32 v10, -2, v10
    v_min_u32 v11, -2, v11
    global_store_dwordx4 v0, v[8:11], s[30:31] sc1
KF_EQ:
    s_cmp_lg_u32 s9, s8
    s_cbranch_scc1 KF_NQ
    s_lshl_b32 s16, s14, 2
    s_add_u32 s16, s16, 132400
    v_mov_b32 v3, s16
    s_cmp_eq_u32 s14, 0
    s_cbranch_scc1 KF_Q0
    ds_write_b128 v0, v[88:91] offset:53248
    ds_write_b128 v0, v[92:95] offset:54272
    ds_write_b128 v0, v[96:99] offset:55296
    ds_write_b128 v0, v[100:103] offset:56320
    s_branch KF_Q1
KF_Q0:
    ds_write_b128 v0, v[72:75] offset:49152
    ds_write_b128 v0, v[76:79] offset:50176
    ds_write_b128 v0, v[80:83] offset:51200
    ds_write_b128 v0, v[84:87] offset:52224
KF_Q1:
    ds_write_b32 v3, v7
    s_waitcnt lgkmcnt(0)
KF_NQ:
    s_endpgm
KF_SPIN3_0:
    s_sleep 1
    ds_read_b32 v8, v6
    s_waitcnt lgkmcnt(0)
    v_cmp_ge_u32 vcc, v7, v8
    s_cbranch_vccnz KF_SPIN3_0
    s_branch KF_GO3_0
KF_SPIN8_0:
    s_sleep 1
    ds_read_b32 v8, v6
    s_waitcnt lgkmcnt(0)
    v_cmp_ge_u32 vcc, v7, v8
    s_cbranch_vccnz KF_SPIN8_0
    s_branch KF_GO8_0
KF_SPIN3_1:
    s_sleep 1
    ds_read_b32 v8, v6
    s_waitcnt lgkmcnt(0)
    v_cmp_ge_u32 vcc, v7, v8
    s_cbranch_vccnz KF_SPIN3_1
    s_branch KF_GO3_1
KF_SPIN8_1:
    s_sleep 1
    ds_read_b32 v8, v6
    s_waitcnt lgkmcnt(0)
    v_cmp_ge_u32 vcc, v7, v8
    s_cbranch_vccnz KF_SPIN8_1
    s_branch KF_GO8_1
KF_SPIN3_2:
    s_sleep 1
    ds_read_b32 v8, v6
    s_waitcnt lgkmcnt(0)
    v_cmp_ge_u32 vcc, v7, v8
    s_cbranch_vccnz KF_SPIN3_2
    s_branch KF_GO3_2
KF_SPIN8_2:
    s_sleep 1
    ds_read_b32 v8, v6
    s_waitcnt lgkmcnt(0)
    v_cmp_ge_u32 vcc, v7, v8
    s_cbranch_vccnz KF_SPIN8_2
    s_branch KF_GO8_2
KF_L8:
    s_cmp_eq_u32 s6, 8
    s_cselect_b32 s22, s40, s38
    s_cselect_b32 s23, s41, s39
    s_add_u32 s22, s22, s24
    s_addc_u32 s23, s23, 0
    s_load_dword s83, s[22:23], 0
    s_load_dword s83, s[22:23], 2048
    s_load_dword s83, s[22:23], 4096
    s_load_dword s83, s[22:23], 6144
    s_load_dword s83, s[22:23], 8192
    s_lshl_b32 s16, s8, 13
    s_add_u32 s16, s16, 0x700000
    v_lshl_add_u32 v2, v9, 7, s16
    s_lshl_b32 s16, s6, 6
    s_sub_u32 s16, 295, s16
    v_mov_b32 v3, s16
    v_mad_u32_u24 v3, v9, 40, v3
    v_and_b32 v5, 255, v3
    s_movk_i32 s16, 103
    v_cmp_gt_u32 s[86:87], s16, v5
    v_cmp_le_i32 vcc, 0, v3
    s_movk_i32 s16, 768
    s_and_b64 s[86:87], s[86:87], vcc
    v_cmp_gt_i32 vcc, s16, v3
    s_movk_i32 s16, 256
    s_and_b64 s[76:77], s[86:87], vcc
    v_cmp_gt_i32 vcc, s16, v3
    s_and_b32 s79, s87, 0x0fffffff
    s_or_b32 s79, s79, 0x08000000
    s_cmp_eq_u32 s8, 3
    s_cselect_b32 s87, s79, s87
    s_and_b32 s78, s86, vcc_lo
    s_mov_b32 s79, 0
    s_waitcnt vmcnt(0)
    v_lshlrev_b32 v20, 16, v12
    v_lshlrev_b32 v28, 16, v16
    v_and_b32 v21, s3, v12
    v_and_b32 v29, s3, v16
    v_lshlrev_b32 v22, 16, v13
    v_lshlrev_b32 v30, 16, v17
    v_and_b32 v23, s3, v13
    v_and_b32 v31, s3, v17
    v_lshlrev_b32 v24, 16, v14
    v_lshlrev_b32 v32, 16, v18
    v_and_b32 v25, s3, v14
    v_and_b32 v33, s3, v18
    v_lshlrev_b32 v26, 16, v15
    v_lshlrev_b32 v34, 16, v19
    v_and_b32 v27, s3, v15
    v_and_b32 v35, s3, v19
    v_pk_add_f32 v[36:37], v[20:21], v[22:23]
    v_pk_add_f32 v[42:43], v[28:29], v[30:31]
    v_pk_add_f32 v[38:39], v[24:25], v[26:27]
    v_pk_add_f32 v[44:45], v[32:33], v[34:35]
    v_pk_add_f32 v[36:37], v[36:37], v[38:39]
    v_pk_add_f32 v[42:43], v[42:43], v[44:45]
    v_add_f32 v36, v36, v37
    v_add_f32 v42, v42, v43
    s_nop 0
    v_add_f32_dpp v36, v36, v36 quad_perm:[1,0,3,2] row_mask:0xf bank_mask:0xf
    v_add_f32_dpp v42, v42, v42 quad_perm:[1,0,3,2] row_mask:0xf bank_mask:0xf
    s_nop 0
    v_add_f32_dpp v36, v36, v36 quad_perm:[2,3,0,1] row_mask:0xf bank_mask:0xf
    v_add_f32_dpp v42, v42, v42 quad_perm:[2,3,0,1] row_mask:0xf bank_mask:0xf
    s_nop 0
    v_add_f32_dpp v36, v36, v36 row_half_mirror row_mask:0xf bank_mask:0xf
    v_add_f32_dpp v42, v42, v42 row_half_mirror row_mask:0xf bank_mask:0xf
    v_mul_f32 v36, 0xbc800000, v36
    v_mul_f32 v42, 0xbc800000, v42
    v_pk_add_f32 v[20:21], v[20:21], v[36:37] op_sel_hi:[1,0]
    v_pk_add_f32 v[28:29], v[28:29], v[42:43] op_sel_hi:[1,0]
    v_pk_add_f32 v[22:23], v[22:23], v[36:37] op_sel_hi:[1,0]
    v_pk_add_f32 v[30:31], v[30:31], v[42:43] op_sel_hi:[1,0]
    v_pk_add_f32 v[24:25], v[24:25], v[36:37] op_sel_hi:[1,0]
    v_pk_add_f32 v[32:33], v[32:33], v[42:43] op_sel_hi:[1,0]
    v_pk_add_f32 v[26:27], v[26:27], v[36:37] op_sel_hi:[1,0]
    v_pk_add_f32 v[34:35], v[34:35], v[42:43] op_sel_hi:[1,0]
    v_pk_mul_f32 v[38:39], v[20:21], v[20:21]
    v_pk_mul_f32 v[44:45], v[28:29], v[28:29]
    v_pk_mul_f32 v[40:41], v[22:23], v[22:23]
    v_pk_mul_f32 v[46:47], v[30:31], v[30:31]
    v_pk_fma_f32 v[38:39], v[24:25], v[24:25], v[38:39]
    v_pk_fma_f32 v[44:45], v[32:33], v[32:33], v[44:45]
    v_pk_fma_f32 v[40:41], v[26:27], v[26:27], v[40:41]
    v_pk_fma_f32 v[46:47], v[34:35], v[34:35], v[46:47]
    v_pk_add_f32 v[38:39], v[38:39], v[40:41]
    v_pk_add_f32 v[44:45], v[44:45], v[46:47]
    v_add_f32 v36, v38, v39
    v_add_f32 v42, v44, v45
    s_nop 0
    v_add_f32_dpp v36, v36, v36 quad_perm:[1,0,3,2] row_mask:0xf bank_mask:0xf
    v_add_f32_dpp v42, v42, v42 quad_perm:[1,0,3,2] row_mask:0xf bank_mask:0xf
    s_nop 0
    v_add_f32_dpp v36, v36, v36 quad_perm:[2,3,0,1] row_mask:0xf bank_mask:0xf
    v_add_f32_dpp v42, v42, v42 quad_perm:[2,3,0,1] row_mask:0xf bank_mask:0xf
    s_nop 0
    v_add_f32_dpp v36, v36, v36 row_half_mirror row_mask:0xf bank_mask:0xf
    v_add_f32_dpp v42, v42, v42 row_half_mirror row_mask:0xf bank_mask:0xf
    v_mov_b32 v38, 0x3727c5ac
    v_mov_b32 v44, 0x3727c5ac
    v_fmac_f32 v38, 0x3c800000, v36
    v_fmac_f32 v44, 0x3c800000, v42
    v_rsq_f32 v36, v38
    v_rsq_f32 v42, v44
    v_pk_mul_f32 v[20:21], v[20:21], v[36:37] op_sel_hi:[1,0]
    v_pk_mul_f32 v[28:29], v[28:29], v[42:43] op_sel_hi:[1,0]
    v_pk_mul_f32 v[22:23], v[22:23], v[36:37] op_sel_hi:[1,0]
    v_pk_mul_f32 v[30:31], v[30:31], v[42:43] op_sel_hi:[1,0]
    v_pk_mul_f32 v[24:25], v[24:25], v[36:37] op_sel_hi:[1,0]
    v_pk_mul_f32 v[32:33], v[32:33], v[42:43] op_sel_hi:[1,0]
    v_pk_mul_f32 v[26:27], v[26:27], v[36:37] op_sel_hi:[1,0]
    v_pk_mul_f32 v[34:35], v[34:35], v[42:43] op_sel_hi:[1,0]
    v_cndmask_b32 v38, v27, 1.0, s[68:69]
    v_cndmask_b32 v44, v35, 1.0, s[70:71]
    v_cvt_pk_bf16_f32 v48, v20, v21
    v_cvt_pk_bf16_f32 v52, v28, v29
    v_cvt_pk_bf16_f32 v49, v22, v23
    v_cvt_pk_bf16_f32 v53, v30, v31
    v_cvt_pk_bf16_f32 v50, v24, v25
    v_cvt_pk_bf16_f32 v54, v32, v33
    v_cvt_pk_bf16_f32 v51, v26, v38
    v_cvt_pk_bf16_f32 v55, v34, v44
    ds_write_b128 v62, v[48:51]
    ds_write_b128 v63, v[52:55]
    s_branch KF_B2M
KF_PAD:
    s_cmp_lt_u32 s6, 5
    s_cbranch_scc0 KF_SG
    s_lshl_b32 s16, s6, 12
    s_add_u32 s16, s16, 20480
    v_add_u32 v40, s16, v10
    v_mov_b64 v[36:37], 0
    v_mov_b64 v[38:39], 0
    global_store_dwordx4 v40, v[36:39], s[72:73] offset:0 sc1
    global_store_dwordx4 v40, v[36:39], s[72:73] offset:1024 sc1
    global_store_dwordx4 v40, v[36:39], s[72:73] offset:2048 sc1
    global_store_dwordx4 v40, v[36:39], s[72:73] offset:3072 sc1
    s_nop 1
    s_branch KF_SG
KF_MLD:
    s_setprio 3
    v_lshrrev_b32 v1, 4, v9
    v_xor_b32 v1, v1, v9
    v_lshlrev_b32 v4, 4, v1
    v_xor_b32 v5, 64, v4
    s_and_b32 s16, s6, 1
    s_lshl_b32 s17, s16, 13
    s_add_u32 s17, s17, 65536
    s_mov_b32 m0, s17
    s_mov_b32 s62, 8192
    s_movk_i32 s18, 4096
    s_cmp_eq_u32 s16, 1
    s_waitcnt lgkmcnt(0)
    s_cselect_b32 s60, s48, s46
    s_cselect_b32 s61, s49, s47
    buffer_load_dwordx4 v4, s[60:63], 0 offen offset:0 lds
    buffer_load_dwordx4 v5, s[60:63], 0 offen offset:1024 lds
    buffer_load_dwordx4 v4, s[60:63], 0 offen offset:2048 lds
    buffer_load_dwordx4 v5, s[60:63], 0 offen offset:3072 lds
    s_add_u32 m0, s17, 4096
    s_nop 0
    buffer_load_dwordx4 v4, s[60:63], s18 offen offset:0 lds
    buffer_load_dwordx4 v5, s[60:63], s18 offen offset:1024 lds
    buffer_load_dwordx4 v4, s[60:63], s18 offen offset:2048 lds
    buffer_load_dwordx4 v5, s[60:63], s18 offen offset:3072 lds
    s_setprio 0
    s_barrier
    s_mov_b32 s4, s58
    s_mov_b32 s5, s59
    s_mov_b32 s80, s56
    s_mov_b32 s81, s57
    v_and_b32 v1, 31, v9
    v_lshrrev_b32 v2, 5, v9
    v_and_b32 v3, 0x13, v1
    v_and_b32 v4, 4, v1
    v_lshl_or_b32 v3, v4, 1, v3
    v_and_b32 v4, 8, v1
    v_lshrrev_b32 v4, 1, v4
    v_or_b32 v3, v3, v4
    v_bfe_u32 v4, v3, 1, 3
    v_xor_b32 v4, v4, v2
    v_lshlrev_b32 v4, 4, v4
    v_lshl_add_u32 v4, v3, 7, v4
    v_add_u32 v20, 65536, v4
    v_xor_b32 v21, 32, v20
    v_xor_b32 v22, 64, v20
    v_xor_b32 v23, 96, v20
    s_lshl_b32 s17, s16, 12
    v_add_u32 v24, s17, v20
    v_add_u32 v25, s17, v21
    v_add_u32 v26, s17, v22
    v_add_u32 v27, s17, v23
    v_lshlrev_b32 v2, 4, v2
    v_sub_u32 v12, 81808, v2
    s_mov_b32 s3, 0x80008000
    s_add_u32 s17, s17, 98304
    v_add_u32 v14, s17, v10
    v_mov_b32 v16, 0x3e38aa3b
    s_lshl_b32 s16, s16, 2
    s_add_u32 s16, s16, 132416
    v_mov_b32 v18, s16
    v_xor_b32 v13, 4, v18
    s_lshl_b32 s16, s8, 13
    s_add_u32 s16, s16, 0x700000
    v_lshl_add_u32 v2, v9, 7, s16
    s_lshl_b32 s16, s6, 6
    s_sub_u32 s16, 295, s16
    v_mov_b32 v3, s16
    v_mad_u32_u24 v3, v9, 40, v3
    v_and_b32 v5, 255, v3
    s_movk_i32 s16, 103
    v_cmp_gt_u32 s[86:87], s16, v5
    v_cmp_le_i32 vcc, 0, v3
    s_movk_i32 s16, 768
    s_and_b64 s[86:87], s[86:87], vcc
    v_cmp_gt_i32 vcc, s16, v3
    s_movk_i32 s16, 256
    s_and_b64 s[76:77], s[86:87], vcc
    v_cmp_gt_i32 vcc, s16, v3
    s_and_b32 s79, s87, 0x0fffffff
    s_or_b32 s79, s79, 0x08000000
    s_cmp_eq_u32 s8, 3
    s_cselect_b32 s87, s79, s87
    s_and_b32 s78, s86, vcc_lo
    s_mov_b32 s79, 0
    s_setprio 2
    s_waitcnt vmcnt(0)
    ds_write_b32 v18, v18
KF_MS:
    ds_read_b32 v19, v13
    s_waitcnt lgkmcnt(0)
    v_cmp_eq_u32 vcc, 0, v19
    s_cbranch_vccz KF_MG
    s_sleep 1
    s_branch KF_MS
KF_MG:
    ds_read_b128 v[76:79], v24 offset:8192
    ds_read_b128 v[60:63], v20 offset:4096
    ds_read_b128 v[80:83], v25 offset:8192
    ds_read_b128 v[64:67], v21 offset:4096
    ds_read_b128 v[84:87], v26 offset:8192
    ds_read_b128 v[68:71], v22 offset:4096
    ds_read_b128 v[88:91], v27 offset:8192
    ds_read_b128 v[72:75], v23 offset:4096
    ds_read_b128 v[28:31], v12 offset:96
    ds_read_b128 v[32:35], v12 offset:64
    ds_read_b128 v[36:39], v12 offset:32
    ds_read_b128 v[40:43], v12 offset:0
    s_waitcnt lgkmcnt(10)
    v_mfma_f32_32x32x16_bf16 v[108:123], v[60:63], v[76:79], 0
    ds_read_b128 v[44:47], v20
    s_waitcnt lgkmcnt(9)
    v_mfma_f32_32x32x16_bf16 v[108:123], v[64:67], v[80:83], v[108:123]
    ds_read_b128 v[48:51], v21
    s_waitcnt lgkmcnt(8)
    v_mfma_f32_32x32x16_bf16 v[108:123], v[68:71], v[84:87], v[108:123]
    ds_read_b128 v[52:55], v22
    s_waitcnt lgkmcnt(7)
    v_mfma_f32_32x32x16_bf16 v[108:123], v[72:75], v[88:91], v[108:123]
    ds_read_b128 v[56:59], v23
    s_waitcnt lgkmcnt(4)
    v_xor_b32 v28, s3, v28
    v_xor_b32 v29, s3, v29
    v_xor_b32 v30, s3, v30
    v_xor_b32 v31, s3, v31
    v_xor_b32 v32, s3, v32
    v_xor_b32 v33, s3, v33
    v_xor_b32 v34, s3, v34
    v_xor_b32 v35, s3, v35
    v_xor_b32 v36, s3, v36
    v_xor_b32 v37, s3, v37
    v_xor_b32 v38, s3, v38
    v_xor_b32 v39, s3, v39
    v_xor_b32 v40, s3, v40
    v_xor_b32 v41, s3, v41
    v_xor_b32 v42, s3, v42
    v_xor_b32 v43, s3, v43
    s_waitcnt lgkmcnt(0)
    v_mfma_f32_32x32x16_bf16 v[108:123], v[60:63], v[28:31], v[108:123]
    v_mfma_f32_32x32x16_bf16 v[108:123], v[64:67], v[32:35], v[108:123]
    v_mfma_f32_32x32x16_bf16 v[108:123], v[68:71], v[36:39], v[108:123]
    v_mfma_f32_32x32x16_bf16 v[108:123], v[72:75], v[40:43], v[108:123]
    v_mfma_f32_32x32x16_bf16 v[92:107], v[44:47], v[76:79], 0
    v_mfma_f32_32x32x16_bf16 v[92:107], v[48:51], v[80:83], v[92:107]
    v_mfma_f32_32x32x16_bf16 v[92:107], v[52:55], v[84:87], v[92:107]
    v_mfma_f32_32x32x16_bf16 v[92:107], v[56:59], v[88:91], v[92:107]
    v_mfma_f32_32x32x16_bf16 v[92:107], v[44:47], v[28:31], v[92:107]
    v_mfma_f32_32x32x16_bf16 v[92:107], v[48:51], v[32:35], v[92:107]
    v_mfma_f32_32x32x16_bf16 v[92:107], v[52:55], v[36:39], v[92:107]
    v_mfma_f32_32x32x16_bf16 v[92:107], v[56:59], v[40:43], v[92:107]
    s_nop 3
    v_mul_f32 v18, v16, v123
    v_mul_f32 v20, v16, v123
    s_nop 1
    v_permlane32_swap_b32 v18, v20
    v_pk_fma_f32 v[108:109], v[108:109], v[16:17], v[20:21] op_sel_hi:[1,0,0] neg_lo:[0,0,1] neg_hi:[0,0,1]
    v_pk_fma_f32 v[110:111], v[110:111], v[16:17], v[20:21] op_sel_hi:[1,0,0] neg_lo:[0,0,1] neg_hi:[0,0,1]
    v_pk_fma_f32 v[112:113], v[112:113], v[16:17], v[20:21] op_sel_hi:[1,0,0] neg_lo:[0,0,1] neg_hi:[0,0,1]
    v_pk_fma_f32 v[114:115], v[114:115], v[16:17], v[20:21] op_sel_hi:[1,0,0] neg_lo:[0,0,1] neg_hi:[0,0,1]
    v_pk_fma_f32 v[116:117], v[116:117], v[16:17], v[20:21] op_sel_hi:[1,0,0] neg_lo:[0,0,1] neg_hi:[0,0,1]
    v_pk_fma_f32 v[118:119], v[118:119], v[16:17], v[20:21] op_sel_hi:[1,0,0] neg_lo:[0,0,1] neg_hi:[0,0,1]
    v_pk_fma_f32 v[120:121], v[120:121], v[16:17], v[20:21] op_sel_hi:[1,0,0] neg_lo:[0,0,1] neg_hi:[0,0,1]
    v_pk_fma_f32 v[122:123], v[122:123], v[16:17], v[20:21] op_sel_hi:[1,0,0] neg_lo:[0,0,1] neg_hi:[0,0,1]
    v_cvt_pk_bf16_f32 v108, v108, v109
    v_cvt_pk_bf16_f32 v109, v110, v111
    v_cvt_pk_bf16_f32 v110, v112, v113
    v_cvt_pk_bf16_f32 v111, v114, v115
    v_cvt_pk_bf16_f32 v112, v116, v117
    v_cvt_pk_bf16_f32 v113, v118, v119
    v_cvt_pk_bf16_f32 v114, v120, v121
    v_cvt_pk_bf16_f32 v115, v122, v123
    ds_write_b128 v14, v[108:111] offset:2048
    ds_write_b128 v14, v[112:115] offset:3072
    v_pk_fma_f32 v[92:93], v[92:93], v[16:17], v[20:21] op_sel_hi:[1,0,0] neg_lo:[0,0,1] neg_hi:[0,0,1]
    v_pk_fma_f32 v[94:95], v[94:95], v[16:17], v[20:21] op_sel_hi:[1,0,0] neg_lo:[0,0,1] neg_hi:[0,0,1]
    v_pk_fma_f32 v[96:97], v[96:97], v[16:17], v[20:21] op_sel_hi:[1,0,0] neg_lo:[0,0,1] neg_hi:[0,0,1]
    v_pk_fma_f32 v[98:99], v[98:99], v[16:17], v[20:21] op_sel_hi:[1,0,0] neg_lo:[0,0,1] neg_hi:[0,0,1]
    v_pk_fma_f32 v[100:101], v[100:101], v[16:17], v[20:21] op_sel_hi:[1,0,0] neg_lo:[0,0,1] neg_hi:[0,0,1]
    v_pk_fma_f32 v[102:103], v[102:103], v[16:17], v[20:21] op_sel_hi:[1,0,0] neg_lo:[0,0,1] neg_hi:[0,0,1]
    v_pk_fma_f32 v[104:105], v[104:105], v[16:17], v[20:21] op_sel_hi:[1,0,0] neg_lo:[0,0,1] neg_hi:[0,0,1]
    v_pk_fma_f32 v[106:107], v[106:107], v[16:17], v[20:21] op_sel_hi:[1,0,0] neg_lo:[0,0,1] neg_hi:[0,0,1]
    v_cvt_pk_bf16_f32 v92, v92, v93
    v_cvt_pk_bf16_f32 v93, v94, v95
    v_cvt_pk_bf16_f32 v94, v96, v97
    v_cvt_pk_bf16_f32 v95, v98, v99
    v_cvt_pk_bf16_f32 v96, v100, v101
    v_cvt_pk_bf16_f32 v97, v102, v103
    v_cvt_pk_bf16_f32 v98, v104, v105
    v_cvt_pk_bf16_f32 v99, v106, v107
    ds_write_b128 v14, v[92:95] offset:0
    ds_write_b128 v14, v[96:99] offset:1024
    s_cmp_eq_u32 s6, 10
    s_cbranch_scc1 KF_B2M
    v_and_b32 v12, 3, v9
    v_lshlrev_b32 v12, 2, v12
    s_mov_b32 s82, 1048576
    s_lshl_b32 s17, s2, 7
    s_add_u32 s17, s17, 0x700000
    v_mov_b32 v13, s17
    v_mov_b32 v8, 4
    v_mov_b32 v18, 132392
    s_setprio 0
KF_CW1:
    global_load_dword v19, v12, s[80:81] sc1
    s_waitcnt vmcnt(0)
    v_cmp_eq_u32 vcc, 0, v19
    s_cbranch_vccz KF_CG1
    s_sub_u32 s82, s82, 1
    s_cbranch_scc1 KF_CG1
    ds_read_b32 v19, v18
    s_waitcnt lgkmcnt(0)
    v_cmp_le_u32 vcc, 4, v19
    s_cbranch_vccnz KF_B2A
    s_sleep 2
    s_branch KF_CW1
KF_CG1:
    s_mov_b64 exec, 1
    ds_write_b32 v18, v8 offset:36
    ds_add_rtn_u32 v19, v18, v8
    s_waitcnt lgkmcnt(0)
    v_cmp_eq_u32 vcc, 20, v19
    s_cbranch_vccz KF_A1
    global_store_dword v13, v8, s[4:5] sc1
KF_A1:
    s_mov_b64 exec, -1
KF_B2M:
    v_mov_b32 v18, 132392
    s_waitcnt lgkmcnt(0)
    s_barrier
KF_CL:
    ds_read_b32 v19, v18 offset:36
    s_waitcnt lgkmcnt(0)
    v_cmp_eq_u32 vcc, 0, v19
    s_cbranch_vccz KF_CE
    s_sleep 1
    s_branch KF_CL
KF_B2A:
    s_barrier
KF_CW2:
    global_load_dword v19, v12, s[80:81] sc1
    s_waitcnt vmcnt(0)
    v_cmp_eq_u32 vcc, 0, v19
    s_cbranch_vccz KF_CG2
    s_sub_u32 s82, s82, 1
    s_cbranch_scc1 KF_CG2
    s_sleep 2
    s_branch KF_CW2
KF_CG2:
    s_mov_b64 exec, 1
    ds_write_b32 v18, v8 offset:36
    ds_add_rtn_u32 v19, v18, v8
    s_waitcnt lgkmcnt(0)
    v_cmp_eq_u32 vcc, 20, v19
    s_cbranch_vccz KF_A2
    global_store_dword v13, v8, s[4:5] sc1
KF_A2:
    s_mov_b64 exec, -1
KF_CE:
    s_mov_b64 exec, s[76:77]
    global_load_dword v3, v2, s[4:5] sc1
    s_mov_b64 exec, -1
KF_HELP:
    s_setprio 3
    s_sub_u32 s9, s6, 8
    v_mov_b32 v0, v9
    v_mov_b32 v1, v10
    s_mul_i32 s16, s9, 3072
    s_min_u32 s16, s16, 8192
    s_add_u32 s17, s16, 135168
    v_add_u32 v71, s17, v1
    s_mul_i32 s24, s2, 11264
    s_add_u32 s24, s24, s16
    s_add_u32 s24, s24, 0x400000
    v_add_u32 v72, s24, v1
    s_mov_b32 s82, 1048576
    s_mul_i32 s14, s8, 327680
    s_lshl_b32 s15, s9, 13
    s_add_u32 s15, s15, 32768
    s_add_u32 s14, s14, s15
    s_mov_b32 s32, s4
    s_mov_b32 s33, s5
    s_mov_b32 s34, 0x140000
    s_mov_b32 s35, 0x20000
    v_and_b32 v14, 7, v0
    s_lshl_b32 s16, s9, 2
    s_add_u32 s16, s16, 132096
    v_lshl_add_u32 v42, v14, 5, s16
    s_lshl_b32 s16, s2, 7
    s_add_u32 s16, s16, 0x700000
    v_mov_b32 v40, s16
    v_mov_b32 v13, 2
    v_mov_b32 v7, 132384
    v_mov_b32 v8, 4
    v_mov_b32 v15, 1
    v_add_u32 v70, 133120, v1
    s_andn2_b32 s86, s86, s76
    s_waitcnt vmcnt(0)
KF_Z1:
    v_cmp_eq_u32 vcc, 0, v3
    s_sub_u32 s82, s82, 1
    s_cselect_b32 s82, 0, s82
    s_cselect_b32 s76, 0, s76
    s_and_b32 s76, s76, vcc_lo
    s_and_b32 s17, s76, s78
    s_cbranch_scc0 KF_Z2
    s_sleep 2
    s_mov_b64 exec, s[76:77]
    global_load_dword v3, v2, s[4:5] sc1
    s_mov_b64 exec, -1
    s_waitcnt vmcnt(0)
    s_branch KF_Z1
KF_Z2:
    s_mov_b32 m0, s15
    s_add_u32 s18, s14, 4096
    buffer_load_dwordx4 v1, s[32:35], s14 offen offset:0 sc1 lds
    buffer_load_dwordx4 v1, s[32:35], s14 offen offset:1024 sc1 lds
    buffer_load_dwordx4 v1, s[32:35], s14 offen offset:2048 sc1 lds
    buffer_load_dwordx4 v1, s[32:35], s14 offen offset:3072 sc1 lds
    s_add_u32 m0, s15, 4096
    s_add_u32 s14, s14, 32768
    buffer_load_dwordx4 v1, s[32:35], s18 offen offset:0 sc1 lds
    buffer_load_dwordx4 v1, s[32:35], s18 offen offset:1024 sc1 lds
    buffer_load_dwordx4 v1, s[32:35], s18 offen offset:2048 sc1 lds
    buffer_load_dwordx4 v1, s[32:35], s18 offen offset:3072 sc1 lds
    s_add_u32 s15, s15, 32768
    s_and_b32 s15, s15, 0x1ffff
    s_cmp_eq_u32 s76, 0
    s_cbranch_scc1 KF_Z6
KF_Z5:
    s_mov_b64 exec, s[76:77]
    global_load_dword v3, v2, s[4:5] sc1
    s_mov_b64 exec, -1
    s_waitcnt vmcnt(0)
    ds_write_b32 v42, v13
    v_cmp_eq_u32 vcc, 0, v3
    s_sub_u32 s82, s82, 1
    s_cselect_b32 s82, 0, s82
    s_cselect_b32 s76, 0, s76
    s_and_b32 s76, s76, vcc_lo
    s_cbranch_scc0 KF_Z6
    s_sleep 2
    s_branch KF_Z5
KF_Z6:
    s_mov_b32 m0, s15
    s_add_u32 s18, s14, 4096
    buffer_load_dwordx4 v1, s[32:35], s14 offen offset:0 sc1 lds
    buffer_load_dwordx4 v1, s[32:35], s14 offen offset:1024 sc1 lds
    buffer_load_dwordx4 v1, s[32:35], s14 offen offset:2048 sc1 lds
    buffer_load_dwordx4 v1, s[32:35], s14 offen offset:3072 sc1 lds
    s_add_u32 m0, s15, 4096
    s_add_u32 s14, s14, 32768
    buffer_load_dwordx4 v1, s[32:35], s18 offen offset:0 sc1 lds
    buffer_load_dwordx4 v1, s[32:35], s18 offen offset:1024 sc1 lds
    buffer_load_dwordx4 v1, s[32:35], s18 offen offset:2048 sc1 lds
    buffer_load_dwordx4 v1, s[32:35], s18 offen offset:3072 sc1 lds
    s_add_u32 s15, s15, 32768
    s_and_b32 s15, s15, 0x1ffff
    s_waitcnt vmcnt(8)
    ds_write_b32 v42, v13
    s_mov_b64 exec, 1
    s_waitcnt lgkmcnt(0)
    ds_add_rtn_u32 v4, v7, v15 offset:40
    s_waitcnt lgkmcnt(0)
    v_cmp_eq_u32 vcc, 3, v4
    s_cbranch_vccnz KF_Y0G
KF_Y0:
    s_sleep 1
    ds_read_b32 v4, v7 offset:40
    s_waitcnt lgkmcnt(0)
    v_cmp_eq_u32 vcc, 4, v4
    s_cbranch_vccz KF_Y0
KF_Y0G:
    s_mov_b64 exec, -1
    global_load_dwordx4 v[132:135], v152, s[40:41]
    global_load_dwordx4 v[136:139], v152, s[40:41] offset:1024
    global_load_dwordx2 v[140:141], v153, s[40:41] offset:2048
    global_load_dwordx4 v[142:145], v152, s[38:39]
    global_load_dwordx4 v[146:149], v152, s[38:39] offset:1024
    global_load_dwordx2 v[150:151], v153, s[38:39] offset:2048
    s_mov_b64 exec, s[86:87]
    global_load_dword v9, v2, s[4:5] sc1
    s_mov_b64 exec, -1
    v_mov_b32 v11, 3
    s_waitcnt vmcnt(7)
    ds_write_b32 v42, v11
KF_Z3:
    ds_read_b32 v4, v7 offset:28
    s_waitcnt lgkmcnt(0)
    v_cmp_gt_u32 vcc, 8, v4
    s_cbranch_vccz KF_Z4
    s_sleep 1
    s_branch KF_Z3
KF_Z4:
    s_mov_b32 m0, s15
    s_add_u32 s18, s14, 4096
    buffer_load_dwordx4 v1, s[32:35], s14 offen offset:0 sc1 lds
    buffer_load_dwordx4 v1, s[32:35], s14 offen offset:1024 sc1 lds
    buffer_load_dwordx4 v1, s[32:35], s14 offen offset:2048 sc1 lds
    buffer_load_dwordx4 v1, s[32:35], s14 offen offset:3072 sc1 lds
    s_add_u32 m0, s15, 4096
    s_add_u32 s14, s14, 32768
    buffer_load_dwordx4 v1, s[32:35], s18 offen offset:0 sc1 lds
    buffer_load_dwordx4 v1, s[32:35], s18 offen offset:1024 sc1 lds
    buffer_load_dwordx4 v1, s[32:35], s18 offen offset:2048 sc1 lds
    buffer_load_dwordx4 v1, s[32:35], s18 offen offset:3072 sc1 lds
    s_add_u32 s15, s15, 32768
    s_and_b32 s15, s15, 0x1ffff
    s_waitcnt vmcnt(8)
    v_cmp_eq_u32 vcc, 0, v9
    s_and_b64 s[86:87], s[86:87], vcc
    v_mul_u32_u24 v44, 52429, v132
    v_lshrrev_b32 v44, 19, v44
    v_and_b32 v44, 0x3fc, v44
    v_mad_i32_i24 v132, v44, -10, v132
    v_add_u32 v44, 133120, v44
    ds_add_rtn_u32 v54, v44, v8
    v_mul_u32_u24 v45, 52429, v133
    v_lshrrev_b32 v45, 19, v45
    v_and_b32 v45, 0x3fc, v45
    v_mad_i32_i24 v133, v45, -10, v133
    v_add_u32 v45, 133120, v45
    ds_add_rtn_u32 v55, v45, v8
    v_mul_u32_u24 v46, 52429, v134
    v_lshrrev_b32 v46, 19, v46
    v_and_b32 v46, 0x3fc, v46
    v_mad_i32_i24 v134, v46, -10, v134
    v_add_u32 v46, 133120, v46
    ds_add_rtn_u32 v56, v46, v8
    v_mul_u32_u24 v47, 52429, v135
    v_lshrrev_b32 v47, 19, v47
    v_and_b32 v47, 0x3fc, v47
    v_mad_i32_i24 v135, v47, -10, v135
    v_add_u32 v47, 133120, v47
    ds_add_rtn_u32 v57, v47, v8
    v_mul_u32_u24 v48, 52429, v136
    v_lshrrev_b32 v48, 19, v48
    v_and_b32 v48, 0x3fc, v48
    v_mad_i32_i24 v136, v48, -10, v136
    v_add_u32 v48, 133120, v48
    ds_add_rtn_u32 v58, v48, v8
    v_mul_u32_u24 v49, 52429, v137
    v_lshrrev_b32 v49, 19, v49
    v_and_b32 v49, 0x3fc, v49
    v_mad_i32_i24 v137, v49, -10, v137
    v_add_u32 v49, 133120, v49
    ds_add_rtn_u32 v59, v49, v8
    v_mul_u32_u24 v50, 52429, v138
    v_lshrrev_b32 v50, 19, v50
    v_and_b32 v50, 0x3fc, v50
    v_mad_i32_i24 v138, v50, -10, v138
    v_add_u32 v50, 133120, v50
    ds_add_rtn_u32 v60, v50, v8
    v_mul_u32_u24 v51, 52429, v139
    v_lshrrev_b32 v51, 19, v51
    v_and_b32 v51, 0x3fc, v51
    v_mad_i32_i24 v139, v51, -10, v139
    v_add_u32 v51, 133120, v51
    ds_add_rtn_u32 v61, v51, v8
    v_mul_u32_u24 v52, 52429, v140
    v_lshrrev_b32 v52, 19, v52
    v_and_b32 v52, 0x3fc, v52
    v_mad_i32_i24 v140, v52, -10, v140
    v_add_u32 v52, 133120, v52
    ds_add_rtn_u32 v62, v52, v8
    v_mul_u32_u24 v53, 52429, v141
    v_lshrrev_b32 v53, 19, v53
    v_and_b32 v53, 0x3fc, v53
    v_mad_i32_i24 v141, v53, -10, v141
    v_add_u32 v53, 133120, v53
    ds_add_rtn_u32 v63, v53, v8
    v_lshl_or_b32 v142, v132, 18, v142
    v_lshl_or_b32 v143, v133, 18, v143
    v_lshl_or_b32 v144, v134, 18, v144
    v_lshl_or_b32 v145, v135, 18, v145
    v_lshl_or_b32 v146, v136, 18, v146
    v_lshl_or_b32 v147, v137, 18, v147
    v_lshl_or_b32 v148, v138, 18, v148
    v_lshl_or_b32 v149, v139, 18, v149
    v_lshl_or_b32 v150, v140, 18, v150
    v_lshl_or_b32 v151, v141, 18, v151
    s_mov_b32 s23, 4
    s_mov_b32 s13, 3
    s_mov_b64 exec, 1
    s_waitcnt lgkmcnt(0)
    ds_add_rtn_u32 v4, v7, v15 offset:24
    s_waitcnt lgkmcnt(0)
    v_cmp_eq_u32 vcc, 3, v4
    s_cbranch_vccnz KF_Y1G
KF_Y1:
    s_sleep 1
    ds_read_b32 v4, v7 offset:24
    s_waitcnt lgkmcnt(0)
    v_cmp_eq_u32 vcc, 4, v4
    s_cbranch_vccz KF_Y1
KF_Y1G:
    s_mov_b64 exec, -1
    ds_read_b128 v[88:91], v70
    v_add_u32 v54, 135168, v54
    v_add_u32 v55, 135168, v55
    v_add_u32 v56, 135168, v56
    v_add_u32 v57, 135168, v57
    v_add_u32 v58, 135168, v58
    v_add_u32 v59, 135168, v59
    v_add_u32 v60, 135168, v60
    v_add_u32 v61, 135168, v61
    v_add_u32 v62, 135168, v62
    v_add_u32 v63, 135168, v63
    s_waitcnt lgkmcnt(0)
    v_add_u32 v92, v88, v89
    v_add_u32 v93, v92, v90
    v_add_u32 v94, v93, v91
    v_mov_b32 v95, v94
    s_nop 1
    v_add_u32_dpp v95, v95, v95 row_shr:1 row_mask:0xf bank_mask:0xf bound_ctrl:0
    s_nop 1
    v_add_u32_dpp v95, v95, v95 row_shr:2 row_mask:0xf bank_mask:0xf bound_ctrl:0
    s_nop 1
    v_add_u32_dpp v95, v95, v95 row_shr:4 row_mask:0xf bank_mask:0xf bound_ctrl:0
    s_nop 1
    v_add_u32_dpp v95, v95, v95 row_shr:8 row_mask:0xf bank_mask:0xf bound_ctrl:0
    s_nop 1
    v_add_u32_dpp v95, v95, v95 row_bcast:15 row_mask:0xa bank_mask:0xf
    s_nop 1
    v_add_u32_dpp v95, v95, v95 row_bcast:31 row_mask:0xc bank_mask:0xf
    v_sub_u32 v96, v95, v94
    v_add_u32 v97, v96, v88
    v_add_u32 v98, v96, v92
    v_add_u32 v99, v96, v93
    ds_write_b128 v70, v[96:99] offset:1024
    ds_read_b32 v132, v44 offset:1024
    ds_read_b32 v133, v45 offset:1024
    ds_read_b32 v134, v46 offset:1024
    ds_read_b32 v135, v47 offset:1024
    ds_read_b32 v136, v48 offset:1024
    ds_read_b32 v137, v49 offset:1024
    ds_read_b32 v138, v50 offset:1024
    ds_read_b32 v139, v51 offset:1024
    ds_read_b32 v140, v52 offset:1024
    ds_read_b32 v141, v53 offset:1024
    v_lshl_or_b32 v64, v88, 16, v96
    v_lshl_or_b32 v65, v89, 16, v97
    v_lshl_or_b32 v66, v90, 16, v98
    v_lshl_or_b32 v67, v91, 16, v99
    s_waitcnt lgkmcnt(9)
    v_add_u32 v132, v132, v54
    ds_write_b32 v132, v142
    s_waitcnt lgkmcnt(9)
    v_add_u32 v133, v133, v55
    ds_write_b32 v133, v143
    s_waitcnt lgkmcnt(9)
    v_add_u32 v134, v134, v56
    ds_write_b32 v134, v144
    s_waitcnt lgkmcnt(9)
    v_add_u32 v135, v135, v57
    ds_write_b32 v135, v145
    s_waitcnt lgkmcnt(9)
    v_add_u32 v136, v136, v58
    ds_write_b32 v136, v146
    s_waitcnt lgkmcnt(9)
    v_add_u32 v137, v137, v59
    ds_write_b32 v137, v147
    s_waitcnt lgkmcnt(9)
    v_add_u32 v138, v138, v60
    ds_write_b32 v138, v148
    s_waitcnt lgkmcnt(9)
    v_add_u32 v139, v139, v61
    ds_write_b32 v139, v149
    s_waitcnt lgkmcnt(9)
    v_add_u32 v140, v140, v62
    ds_write_b32 v140, v150
    s_waitcnt lgkmcnt(9)
    v_add_u32 v141, v141, v63
    ds_write_b32 v141, v151
    ds_write_b128 v70, v[64:67] offset:12288
    s_waitcnt vmcnt(0)
    s_cmp_ge_u32 s13, s23
    s_cbranch_scc1 KF_PBA
    s_cmp_eq_u32 s23, 10
    s_cselect_b32 s13, 11, s23
    v_mov_b32 v11, s13
    ds_write_b32 v42, v11
KF_PBA:
    s_cmp_lg_u64 s[86:87], 0
    s_cbranch_scc1 KF_NDA
    s_cmp_ge_u32 s23, 10
    s_cbranch_scc1 KF_NDA
    ds_read_b32 v11, v42 offset:16
    s_sub_u32 s16, s23, 3
    s_waitcnt lgkmcnt(0)
    v_cmp_gt_u32 vcc, s16, v11
    s_cbranch_vccnz KF_NDA
    s_add_u32 s23, s23, 1
    s_mov_b32 m0, s15
    s_add_u32 s18, s14, 4096
    buffer_load_dwordx4 v1, s[32:35], s14 offen offset:0 sc1 lds
    buffer_load_dwordx4 v1, s[32:35], s14 offen offset:1024 sc1 lds
    buffer_load_dwordx4 v1, s[32:35], s14 offen offset:2048 sc1 lds
    buffer_load_dwordx4 v1, s[32:35], s14 offen offset:3072 sc1 lds
    s_add_u32 m0, s15, 4096
    s_add_u32 s14, s14, 32768
    buffer_load_dwordx4 v1, s[32:35], s18 offen offset:0 sc1 lds
    buffer_load_dwordx4 v1, s[32:35], s18 offen offset:1024 sc1 lds
    buffer_load_dwordx4 v1, s[32:35], s18 offen offset:2048 sc1 lds
    buffer_load_dwordx4 v1, s[32:35], s18 offen offset:3072 sc1 lds
    s_add_u32 s15, s15, 32768
    s_and_b32 s15, s15, 0x1ffff
KF_NDA:
    s_mov_b64 exec, 1
    s_waitcnt lgkmcnt(0)
    ds_add_rtn_u32 v4, v7, v15 offset:28
    s_waitcnt lgkmcnt(0)
    v_cmp_eq_u32 vcc, 11, v4
    s_cbranch_vccnz KF_Y2G
KF_Y2:
    s_sleep 1
    ds_read_b32 v4, v7 offset:28
    s_waitcnt lgkmcnt(0)
    v_cmp_eq_u32 vcc, 12, v4
    s_cbranch_vccz KF_Y2
KF_Y2G:
    s_mov_b64 exec, -1
    ds_read_b128 v[44:47], v71 offset:0
    ds_read_b128 v[48:51], v71 offset:1024
    ds_read_b128 v[52:55], v71 offset:2048
    s_cmp_eq_u32 s23, 4
    s_cbranch_scc0 KF_NDB
    s_cmp_ge_u32 s13, s23
    s_cbranch_scc1 KF_PBB
    s_cmp_eq_u32 s23, 10
    s_cselect_b32 s13, 11, s23
    v_mov_b32 v11, s13
    ds_write_b32 v42, v11
KF_PBB:
    s_cmp_lg_u64 s[86:87], 0
    s_cbranch_scc1 KF_NDB
    s_cmp_ge_u32 s23, 10
    s_cbranch_scc1 KF_NDB
    ds_read_b32 v11, v42 offset:16
    s_sub_u32 s16, s23, 3
    s_waitcnt lgkmcnt(0)
    v_cmp_gt_u32 vcc, s16, v11
    s_cbranch_vccnz KF_NDB
    s_add_u32 s23, s23, 1
    s_mov_b32 m0, s15
    s_add_u32 s18, s14, 4096
    buffer_load_dwordx4 v1, s[32:35], s14 offen offset:0 sc1 lds
    buffer_load_dwordx4 v1, s[32:35], s14 offen offset:1024 sc1 lds
    buffer_load_dwordx4 v1, s[32:35], s14 offen offset:2048 sc1 lds
    buffer_load_dwordx4 v1, s[32:35], s14 offen offset:3072 sc1 lds
    s_add_u32 m0, s15, 4096
    s_add_u32 s14, s14, 32768
    buffer_load_dwordx4 v1, s[32:35], s18 offen offset:0 sc1 lds
    buffer_load_dwordx4 v1, s[32:35], s18 offen offset:1024 sc1 lds
    buffer_load_dwordx4 v1, s[32:35], s18 offen offset:2048 sc1 lds
    buffer_load_dwordx4 v1, s[32:35], s18 offen offset:3072 sc1 lds
    s_add_u32 s15, s15, 32768
    s_and_b32 s15, s15, 0x1ffff
KF_NDB:
    s_cmp_ge_u32 s2, 250
    s_waitcnt lgkmcnt(0)
    s_cbranch_scc1 KF_NG
    global_store_dwordx4 v72, v[44:47], s[4:5] offset:0 sc1
    global_store_dwordx4 v72, v[48:51], s[4:5] offset:1024 sc1
    global_store_dwordx4 v72, v[52:55], s[4:5] offset:2048 sc1
KF_NG:
    s_lshl_b32 s16, s9, 6
    v_add_u32 v8, s16, v0
    s_lshl_b32 s17, s2, 2
    v_mul_u32_u24 v12, 11264, v8
    s_add_u32 s17, s17, 10240
    v_add_u32 v3, s17, v12
    s_mul_i32 s24, s2, 80
    s_mul_i32 s16, s9, 20
    s_add_u32 s16, s16, s24
    v_lshrrev_b32 v6, 5, v0
    v_lshl_add_u32 v6, v6, 1, s16
    v_lshlrev_b32 v5, 7, v8
    v_add_u32 v5, 0x700000, v5
    s_movk_i32 s83, 252
    v_cmp_gt_u32 s[84:85], s83, v8
    s_mov_b32 s13, s23
    v_mov_b32 v11, s23
    s_cmp_ge_u32 s2, 250
    s_cbranch_scc1 KF_NW
    s_waitcnt vmcnt(3)
    ds_write_b32 v42, v11
KF_NW:
    s_waitcnt vmcnt(0)
    ds_write_b32 v42, v11
    s_mov_b64 exec, 1
    ds_add_rtn_u32 v4, v7, v13
    s_waitcnt lgkmcnt(0)
    v_cmp_eq_u32 vcc, 6, v4
    s_cbranch_vccz KF_NA
    global_store_dword v40, v13, s[4:5] offset:4 sc1
KF_NA:
    s_mov_b64 exec, -1
    s_cmp_ge_u32 s13, s23
    s_cbranch_scc1 KF_PBC
    s_cmp_eq_u32 s23, 10
    s_cselect_b32 s13, 11, s23
    v_mov_b32 v11, s13
    ds_write_b32 v42, v11
KF_PBC:
    s_cmp_lg_u64 s[86:87], 0
    s_cbranch_scc1 KF_NDC
    s_cmp_ge_u32 s23, 10
    s_cbranch_scc1 KF_NDC
    ds_read_b32 v11, v42 offset:16
    s_sub_u32 s16, s23, 3
    s_waitcnt lgkmcnt(0)
    v_cmp_gt_u32 vcc, s16, v11
    s_cbranch_vccnz KF_NDC
    s_add_u32 s23, s23, 1
    s_mov_b32 m0, s15
    s_add_u32 s18, s14, 4096
    buffer_load_dwordx4 v1, s[32:35], s14 offen offset:0 sc1 lds
    buffer_load_dwordx4 v1, s[32:35], s14 offen offset:1024 sc1 lds
    buffer_load_dwordx4 v1, s[32:35], s14 offen offset:2048 sc1 lds
    buffer_load_dwordx4 v1, s[32:35], s14 offen offset:3072 sc1 lds
    s_add_u32 m0, s15, 4096
    s_add_u32 s14, s14, 32768
    buffer_load_dwordx4 v1, s[32:35], s18 offen offset:0 sc1 lds
    buffer_load_dwordx4 v1, s[32:35], s18 offen offset:1024 sc1 lds
    buffer_load_dwordx4 v1, s[32:35], s18 offen offset:2048 sc1 lds
    buffer_load_dwordx4 v1, s[32:35], s18 offen offset:3072 sc1 lds
    s_add_u32 s15, s15, 32768
    s_and_b32 s15, s15, 0x1ffff
KF_NDC:
    s_setprio 3
    s_mov_b32 s68, s42
    s_mov_b32 s69, s43
    s_mov_b32 s70, 0x4e20
    s_mov_b32 s71, 0x20000
    s_add_u32 s40, s4, 0x400000
    s_addc_u32 s41, s5, 0
    s_mov_b32 s42, 0x2af800
    s_mov_b32 s43, 0x20000
    s_add_u32 s44, s4, 0x280000
    s_addc_u32 s45, s5, 0
    s_or_b32 s45, s45, 0x800000
    s_mov_b32 s46, 0x2710
    s_mov_b32 s47, 0x20000
    v_lshlrev_b32 v15, 4, v14
    v_mov_b64 v[16:17], v[14:15]
    v_mov_b64 v[18:19], v[14:15]
    v_mov_b64 v[20:21], v[14:15]
    v_mov_b64 v[22:23], v[14:15]
    v_mov_b64 v[24:25], v[14:15]
    v_mov_b64 v[26:27], v[14:15]
    v_mov_b64 v[28:29], v[14:15]
    v_mov_b64 v[30:31], v[14:15]
    v_mov_b64 v[32:33], v[14:15]
    v_mov_b64 v[34:35], v[14:15]
    v_mov_b64 v[128:129], v[14:15]
    v_mov_b64 v[130:131], v[14:15]
    v_mov_b64 v[132:133], v[14:15]
    v_mov_b64 v[134:135], v[14:15]
    v_mov_b64 v[136:137], v[14:15]
    v_mov_b64 v[138:139], v[14:15]
    v_mov_b64 v[140:141], v[14:15]
    v_mov_b64 v[142:143], v[14:15]
    v_mov_b64 v[144:145], v[14:15]
    v_mov_b64 v[146:147], v[14:15]
    v_mov_b64 v[152:153], 0
    v_mov_b64 v[154:155], 0
    v_mov_b64 v[156:157], 0
    buffer_load_short_d16_hi v152, v6, s[68:71], 0 offen offset:0
    buffer_load_short_d16_hi v153, v6, s[68:71], 0 offen offset:4
    buffer_load_short_d16_hi v154, v6, s[68:71], 0 offen offset:8
    buffer_load_short_d16_hi v155, v6, s[68:71], 0 offen offset:12
    buffer_load_short_d16_hi v156, v6, s[68:71], 0 offen offset:16
    s_mul_i32 s16, s9, 1280
    s_add_u32 s16, s16, 133120
    v_lshl_add_u32 v41, v0, 2, s16
KF_BW:
    s_mov_b64 exec, s[86:87]
    s_cbranch_execz KF_BX
    global_load_dword v9, v2, s[4:5] sc1
KF_BX:
    s_mov_b64 exec, s[84:85]
    global_load_dword v4, v5, s[4:5] offset:4 sc1
    s_waitcnt vmcnt(0)
    v_cmp_eq_u32 s[84:85], 0, v4
    s_mov_b64 exec, -1
    v_cmp_eq_u32 vcc, 0, v9
    s_and_b64 s[86:87], s[86:87], vcc
    s_cmp_ge_u32 s13, s23
    s_cbranch_scc1 KF_PBW
    s_cmp_eq_u32 s23, 10
    s_cselect_b32 s13, 11, s23
    v_mov_b32 v11, s13
    ds_write_b32 v42, v11
KF_PBW:
    s_cmp_lg_u64 s[86:87], 0
    s_cbranch_scc1 KF_NDW
    s_cmp_ge_u32 s23, 10
    s_cbranch_scc1 KF_NDW
    ds_read_b32 v11, v42 offset:16
    s_sub_u32 s16, s23, 3
    s_waitcnt lgkmcnt(0)
    v_cmp_gt_u32 vcc, s16, v11
    s_cbranch_vccnz KF_NDW
    s_add_u32 s23, s23, 1
    s_mov_b32 m0, s15
    s_add_u32 s18, s14, 4096
    buffer_load_dwordx4 v1, s[32:35], s14 offen offset:0 sc1 lds
    buffer_load_dwordx4 v1, s[32:35], s14 offen offset:1024 sc1 lds
    buffer_load_dwordx4 v1, s[32:35], s14 offen offset:2048 sc1 lds
    buffer_load_dwordx4 v1, s[32:35], s14 offen offset:3072 sc1 lds
    s_add_u32 m0, s15, 4096
    s_add_u32 s14, s14, 32768
    buffer_load_dwordx4 v1, s[32:35], s18 offen offset:0 sc1 lds
    buffer_load_dwordx4 v1, s[32:35], s18 offen offset:1024 sc1 lds
    buffer_load_dwordx4 v1, s[32:35], s18 offen offset:2048 sc1 lds
    buffer_load_dwordx4 v1, s[32:35], s18 offen offset:3072 sc1 lds
    s_add_u32 s15, s15, 32768
    s_and_b32 s15, s15, 0x1ffff
KF_NDW:
    s_or_b64 vcc, s[84:85], s[86:87]
    s_cbranch_scc0 KF_BR
    s_sub_u32 s82, s82, 1
    s_cbranch_scc1 KF_TO
    s_sleep 6
    s_branch KF_BW
KF_TO:
    s_mov_b32 s82, 0
    s_mov_b32 s42, 0
KF_BR:
    buffer_load_dword v4, v3, s[40:43], 0 offen sc1
    s_waitcnt vmcnt(0)
    v_and_b32 v5, 0xffff, v4
    v_add_u32 v12, v12, v5
    v_lshrrev_b32 v4, 18, v4
KF_EL:
    v_cmpx_lt_i32 vcc, 0, v4
    buffer_load_dwordx4 v[44:47], v12, s[40:43], 0 offen offset:0 sc1
    v_cmpx_lt_i32 vcc, 4, v4
    buffer_load_dwordx4 v[48:51], v12, s[40:43], 0 offen offset:16 sc1
    v_cmpx_lt_i32 vcc, 8, v4
    buffer_load_dwordx4 v[52:55], v12, s[40:43], 0 offen offset:32 sc1
    v_cmpx_lt_i32 vcc, 12, v4
    buffer_load_dwordx4 v[56:59], v12, s[40:43], 0 offen offset:48 sc1
    v_cmpx_lt_i32 vcc, 16, v4
    buffer_load_dwordx4 v[60:63], v12, s[40:43], 0 offen offset:64 sc1
    v_cmpx_lt_i32 vcc, 20, v4
    buffer_load_dwordx4 v[64:67], v12, s[40:43], 0 offen offset:80 sc1
    s_mov_b64 exec, -1
    s_waitcnt vmcnt(0)
    s_cmp_ge_u32 s13, s23
    s_cbranch_scc1 KF_PBE
    s_cmp_eq_u32 s23, 10
    s_cselect_b32 s13, 11, s23
    v_mov_b32 v11, s13
    ds_write_b32 v42, v11
KF_PBE:
    s_cmp_ge_u32 s23, 10
    s_cbranch_scc1 KF_NDE
    ds_read_b32 v11, v42 offset:16
    s_sub_u32 s16, s23, 3
    s_waitcnt lgkmcnt(0)
    v_cmp_gt_u32 vcc, s16, v11
    s_cbranch_vccnz KF_NDE
    s_add_u32 s23, s23, 1
    s_mov_b32 m0, s15
    s_add_u32 s18, s14, 4096
    buffer_load_dwordx4 v1, s[32:35], s14 offen offset:0 sc1 lds
    buffer_load_dwordx4 v1, s[32:35], s14 offen offset:1024 sc1 lds
    buffer_load_dwordx4 v1, s[32:35], s14 offen offset:2048 sc1 lds
    buffer_load_dwordx4 v1, s[32:35], s14 offen offset:3072 sc1 lds
    s_add_u32 m0, s15, 4096
    s_add_u32 s14, s14, 32768
    buffer_load_dwordx4 v1, s[32:35], s18 offen offset:0 sc1 lds
    buffer_load_dwordx4 v1, s[32:35], s18 offen offset:1024 sc1 lds
    buffer_load_dwordx4 v1, s[32:35], s18 offen offset:2048 sc1 lds
    buffer_load_dwordx4 v1, s[32:35], s18 offen offset:3072 sc1 lds
    s_add_u32 s15, s15, 32768
    s_and_b32 s15, s15, 0x1ffff
KF_NDE:
    v_alignbit_b32 v68, 2, v44, 16
    v_cmpx_lt_i32 s[52:53], 0, v4
    ds_add_rtn_u32 v68, v68, v13
    v_alignbit_b32 v69, 2, v45, 16
    v_cmpx_lt_i32 s[54:55], 1, v4
    ds_add_rtn_u32 v69, v69, v13
    v_alignbit_b32 v70, 2, v46, 16
    v_cmpx_lt_i32 s[56:57], 2, v4
    ds_add_rtn_u32 v70, v70, v13
    v_alignbit_b32 v71, 2, v47, 16
    v_cmpx_lt_i32 s[58:59], 3, v4
    ds_add_rtn_u32 v71, v71, v13
    v_alignbit_b32 v72, 2, v48, 16
    v_cmpx_lt_i32 s[60:61], 4, v4
    ds_add_rtn_u32 v72, v72, v13
    v_alignbit_b32 v73, 2, v49, 16
    v_cmpx_lt_i32 s[62:63], 5, v4
    ds_add_rtn_u32 v73, v73, v13
    v_alignbit_b32 v74, 2, v50, 16
    v_cmpx_lt_i32 s[64:65], 6, v4
    ds_add_rtn_u32 v74, v74, v13
    v_alignbit_b32 v75, 2, v51, 16
    v_cmpx_lt_i32 s[66:67], 7, v4
    ds_add_rtn_u32 v75, v75, v13
    s_mov_b64 exec, s[52:53]
    s_waitcnt lgkmcnt(7)
    ds_write_b16 v68, v44
    s_mov_b64 exec, s[54:55]
    s_waitcnt lgkmcnt(7)
    ds_write_b16 v69, v45
    s_mov_b64 exec, s[56:57]
    s_waitcnt lgkmcnt(7)
    ds_write_b16 v70, v46
    s_mov_b64 exec, s[58:59]
    s_waitcnt lgkmcnt(7)
    ds_write_b16 v71, v47
    s_mov_b64 exec, s[60:61]
    s_waitcnt lgkmcnt(7)
    ds_write_b16 v72, v48
    s_mov_b64 exec, s[62:63]
    s_waitcnt lgkmcnt(7)
    ds_write_b16 v73, v49
    s_mov_b64 exec, s[64:65]
    s_waitcnt lgkmcnt(7)
    ds_write_b16 v74, v50
    s_mov_b64 exec, s[66:67]
    s_waitcnt lgkmcnt(7)
    ds_write_b16 v75, v51
    s_cbranch_execz KF_SORTED
    v_alignbit_b32 v76, 2, v52, 16
    v_cmpx_lt_i32 s[52:53], 8, v4
    ds_add_rtn_u32 v76, v76, v13
    v_alignbit_b32 v77, 2, v53, 16
    v_cmpx_lt_i32 s[54:55], 9, v4
    ds_add_rtn_u32 v77, v77, v13
    v_alignbit_b32 v78, 2, v54, 16
    v_cmpx_lt_i32 s[56:57], 10, v4
    ds_add_rtn_u32 v78, v78, v13
    v_alignbit_b32 v79, 2, v55, 16
    v_cmpx_lt_i32 s[58:59], 11, v4
    ds_add_rtn_u32 v79, v79, v13
    v_alignbit_b32 v80, 2, v56, 16
    v_cmpx_lt_i32 s[60:61], 12, v4
    ds_add_rtn_u32 v80, v80, v13
    v_alignbit_b32 v81, 2, v57, 16
    v_cmpx_lt_i32 s[62:63], 13, v4
    ds_add_rtn_u32 v81, v81, v13
    v_alignbit_b32 v82, 2, v58, 16
    v_cmpx_lt_i32 s[64:65], 14, v4
    ds_add_rtn_u32 v82, v82, v13
    v_alignbit_b32 v83, 2, v59, 16
    v_cmpx_lt_i32 s[66:67], 15, v4
    ds_add_rtn_u32 v83, v83, v13
    s_mov_b64 exec, s[52:53]
    s_waitcnt lgkmcnt(7)
    ds_write_b16 v76, v52
    s_mov_b64 exec, s[54:55]
    s_waitcnt lgkmcnt(7)
    ds_write_b16 v77, v53
    s_mov_b64 exec, s[56:57]
    s_waitcnt lgkmcnt(7)
    ds_write_b16 v78, v54
    s_mov_b64 exec, s[58:59]
    s_waitcnt lgkmcnt(7)
    ds_write_b16 v79, v55
    s_mov_b64 exec, s[60:61]
    s_waitcnt lgkmcnt(7)
    ds_write_b16 v80, v56
    s_mov_b64 exec, s[62:63]
    s_waitcnt lgkmcnt(7)
    ds_write_b16 v81, v57
    s_mov_b64 exec, s[64:65]
    s_waitcnt lgkmcnt(7)
    ds_write_b16 v82, v58
    s_mov_b64 exec, s[66:67]
    s_waitcnt lgkmcnt(7)
    ds_write_b16 v83, v59
    s_cbranch_execz KF_SORTED
    v_alignbit_b32 v84, 2, v60, 16
    v_cmpx_lt_i32 s[52:53], 16, v4
    ds_add_rtn_u32 v84, v84, v13
    v_alignbit_b32 v85, 2, v61, 16
    v_cmpx_lt_i32 s[54:55], 17, v4
    ds_add_rtn_u32 v85, v85, v13
    v_alignbit_b32 v86, 2, v62, 16
    v_cmpx_lt_i32 s[56:57], 18, v4
    ds_add_rtn_u32 v86, v86, v13
    v_alignbit_b32 v87, 2, v63, 16
    v_cmpx_lt_i32 s[58:59], 19, v4
    ds_add_rtn_u32 v87, v87, v13
    v_alignbit_b32 v88, 2, v64, 16
    v_cmpx_lt_i32 s[60:61], 20, v4
    ds_add_rtn_u32 v88, v88, v13
    v_alignbit_b32 v89, 2, v65, 16
    v_cmpx_lt_i32 s[62:63], 21, v4
    ds_add_rtn_u32 v89, v89, v13
    v_alignbit_b32 v90, 2, v66, 16
    v_cmpx_lt_i32 s[64:65], 22, v4
    ds_add_rtn_u32 v90, v90, v13
    v_alignbit_b32 v91, 2, v67, 16
    v_cmpx_lt_i32 s[66:67], 23, v4
    ds_add_rtn_u32 v91, v91, v13
    s_mov_b64 exec, s[52:53]
    s_waitcnt lgkmcnt(7)
    ds_write_b16 v84, v60
    s_mov_b64 exec, s[54:55]
    s_waitcnt lgkmcnt(7)
    ds_write_b16 v85, v61
    s_mov_b64 exec, s[56:57]
    s_waitcnt lgkmcnt(7)
    ds_write_b16 v86, v62
    s_mov_b64 exec, s[58:59]
    s_waitcnt lgkmcnt(7)
    ds_write_b16 v87, v63
    s_mov_b64 exec, s[60:61]
    s_waitcnt lgkmcnt(7)
    ds_write_b16 v88, v64
    s_mov_b64 exec, s[62:63]
    s_waitcnt lgkmcnt(7)
    ds_write_b16 v89, v65
    s_mov_b64 exec, s[64:65]
    s_waitcnt lgkmcnt(7)
    ds_write_b16 v90, v66
    s_mov_b64 exec, s[66:67]
    s_waitcnt lgkmcnt(7)
    ds_write_b16 v91, v67
    s_mov_b64 exec, -1
    v_subrev_u32 v4, 24, v4
    v_add_u32 v12, 96, v12
    v_cmp_lt_i32 vcc, 0, v4
    s_waitcnt lgkmcnt(0)
    s_cbranch_vccnz KF_EL
KF_SORTED:
    s_mov_b64 exec, -1
    s_lshl_b32 s16, s9, 2
    s_add_u32 s16, s16, 132352
    v_mov_b32 v43, s16
    s_waitcnt lgkmcnt(0)
    ds_write_b32 v43, v13
    v_and_b32 v3, 3, v0
    v_lshlrev_b32 v3, 2, v3
    v_add_u32 v3, 132352, v3
    v_lshlrev_b32 v6, 2, v0
    v_add_u32 v6, 131072, v6
    v_mul_u32_u24 v7, 356, v0
    v_add_u32 v7, 149600, v7
    s_mov_b32 s19, -1
    s_mov_b32 s20, 0
    s_mov_b32 s25, -1
    s_mov_b32 s26, 0
    s_mov_b32 s21, 0
    s_mov_b32 s22, 0
    s_mov_b32 s12, 0
    s_mov_b32 s31, 0
    s_mov_b32 s27, 0
    s_mov_b32 s28, 0
    v_lshrrev_b32 v15, 3, v0
    v_lshlrev_b32 v15, 1, v15
    v_add_u32 v15, 149440, v15
    v_lshlrev_b32 v5, 4, v14
    v_lshrrev_b32 v8, 4, v0
    v_lshl_add_u32 v5, v8, 2, v5
    v_add_u32 v5, 133120, v5
    v_mov_b32 v9, v7
    v_mov_b32 v10, v7
    s_lshl_b32 s16, s2, 2
    s_add_u32 s16, s16, s9
    s_mul_i32 s16, s16, 5120
    s_add_u32 s16, s16, 0x900400
    v_add_u32 v8, s16, v1
    v_mov_b64 v[36:37], -1
    v_mov_b64 v[38:39], -1
    global_store_dwordx4 v8, v[36:39], s[4:5] offset:-1024 sc1
    global_store_dwordx4 v8, v[36:39], s[4:5] offset:0 sc1
    global_store_dwordx4 v8, v[36:39], s[4:5] offset:1024 sc1
    global_store_dwordx4 v8, v[36:39], s[4:5] offset:2048 sc1
    global_store_dwordx4 v8, v[36:39], s[4:5] offset:3072 sc1
    s_setprio 2
KF_PER:
    s_waitcnt vmcnt(10)
    s_cmp_lt_i32 s25, 0
    s_cbranch_scc0 KF_SV0
    s_waitcnt vmcnt(0)
KF_SV0:
    s_cmp_ge_u32 s13, s23
    s_cbranch_scc1 KF_PB0
    s_cmp_eq_u32 s23, 10
    s_cselect_b32 s13, 11, s23
    v_mov_b32 v11, s13
    ds_write_b32 v42, v11
KF_PB0:
    s_cmp_ge_u32 s23, 10
    s_cbranch_scc1 KF_ND0
    ds_read_b32 v11, v42 offset:16
    s_sub_u32 s16, s23, 3
    s_waitcnt lgkmcnt(0)
    v_cmp_gt_u32 vcc, s16, v11
    s_cbranch_vccnz KF_ND0
    s_add_u32 s23, s23, 1
    s_mov_b32 m0, s15
    s_add_u32 s18, s14, 4096
    buffer_load_dwordx4 v1, s[32:35], s14 offen offset:0 sc1 lds
    buffer_load_dwordx4 v1, s[32:35], s14 offen offset:1024 sc1 lds
    buffer_load_dwordx4 v1, s[32:35], s14 offen offset:2048 sc1 lds
    buffer_load_dwordx4 v1, s[32:35], s14 offen offset:3072 sc1 lds
    s_add_u32 m0, s15, 4096
    s_add_u32 s14, s14, 32768
    buffer_load_dwordx4 v1, s[32:35], s18 offen offset:0 sc1 lds
    buffer_load_dwordx4 v1, s[32:35], s18 offen offset:1024 sc1 lds
    buffer_load_dwordx4 v1, s[32:35], s18 offen offset:2048 sc1 lds
    buffer_load_dwordx4 v1, s[32:35], s18 offen offset:3072 sc1 lds
    s_add_u32 s15, s15, 32768
    s_and_b32 s15, s15, 0x1ffff
KF_ND0:
    s_cmp_lg_u32 s12, 0
    s_cbranch_scc1 KF_RDY
    ds_read_b32 v11, v3
    s_waitcnt lgkmcnt(0)
    v_cmp_eq_u32 vcc, 0, v11
    s_cbranch_vccnz KF_IDLE
    ds_read_b32 v4, v6
    s_mov_b32 s12, 1
    s_mul_i32 s21, s9, 10
    s_add_u32 s22, s21, 10
    s_cmp_ge_u32 s2, 250
    s_cselect_b32 s22, s21, s22
    s_waitcnt lgkmcnt(0)
    v_sub_u32 v4, v4, v7
    v_cmp_lt_u32 vcc, 320, v4
    s_cbranch_vccz KF_RDY
    s_mov_b32 s31, 1
    s_mov_b32 s22, s21
KF_RDY:
    s_mov_b32 s29, s19
    s_mov_b32 s30, s20
    s_cmp_gt_i32 s20, 0
    s_cbranch_scc1 KF_CONT0
    s_mov_b32 s19, -1
    s_cmp_ge_u32 s21, s22
    s_cbranch_scc1 KF_CONS0
    s_mov_b32 s19, s21
    v_readlane_b32 s20, v4, s21
    s_mul_i32 s16, s21, 356
    s_add_u32 s21, s21, 1
    v_add_u32 v9, s16, v15
    s_branch KF_RD0
KF_CONT0:
    v_add_u32 v9, 160, v9
KF_RD0:
    s_sub_i32 s20, s20, 160
    ds_read_u16 v16, v9 offset:160
    ds_read_u16 v18, v9 offset:176
    ds_read_u16 v20, v9 offset:192
    ds_read_u16 v22, v9 offset:208
    ds_read_u16 v24, v9 offset:224
    ds_read_u16 v26, v9 offset:240
    ds_read_u16 v28, v9 offset:256
    ds_read_u16 v30, v9 offset:272
    ds_read_u16 v32, v9 offset:288
    ds_read_u16 v34, v9 offset:304
KF_CONS0:
    s_cmp_lt_i32 s29, 0
    s_cbranch_scc1 KF_ISS0
    s_cmp_le_i32 s30, -32
    s_cbranch_scc1 KF_A80
    v_pk_add_f16 v44, v44, v76
    v_pk_add_f16 v45, v45, v77
    v_pk_add_f16 v46, v46, v78
    v_pk_add_f16 v47, v47, v79
    s_cmp_le_i32 s30, -16
    s_cbranch_scc1 KF_A80
    v_pk_add_f16 v48, v48, v80
    v_pk_add_f16 v49, v49, v81
    v_pk_add_f16 v50, v50, v82
    v_pk_add_f16 v51, v51, v83
KF_A80:
    v_pk_add_f16 v44, v44, v60
    v_pk_add_f16 v45, v45, v61
    v_pk_add_f16 v46, v46, v62
    v_pk_add_f16 v47, v47, v63
    v_pk_add_f16 v48, v48, v64
    v_pk_add_f16 v49, v49, v65
    v_pk_add_f16 v50, v50, v66
    v_pk_add_f16 v51, v51, v67
    v_pk_add_f16 v52, v52, v68
    v_pk_add_f16 v53, v53, v69
    v_pk_add_f16 v54, v54, v70
    v_pk_add_f16 v55, v55, v71
    v_pk_add_f16 v56, v56, v72
    v_pk_add_f16 v57, v57, v73
    v_pk_add_f16 v58, v58, v74
    v_pk_add_f16 v59, v59, v75
    v_pk_add_f16 v44, v44, v52
    v_pk_add_f16 v45, v45, v53
    v_pk_add_f16 v46, v46, v54
    v_pk_add_f16 v47, v47, v55
    v_pk_add_f16 v48, v48, v56
    v_pk_add_f16 v49, v49, v57
    v_pk_add_f16 v50, v50, v58
    v_pk_add_f16 v51, v51, v59
    v_pk_add_f16 v44, v44, v48
    v_pk_add_f16 v45, v45, v49
    v_pk_add_f16 v46, v46, v50
    v_pk_add_f16 v47, v47, v51
    s_max_i32 s16, s27, s30
    s_cmp_gt_i32 s16, 0
    s_cbranch_scc1 KF_MC0
KF_FIN0:
    s_lshl_b32 s29, s29, 7
    v_permlane32_swap_b32 v44, v46
    v_permlane32_swap_b32 v45, v47
    v_pk_add_f16 v44, v44, v46
    v_pk_add_f16 v45, v45, v47
    v_add_u32 v8, s29, v5
    s_nop 0
    v_permlane16_swap_b32 v44, v45
    v_pk_add_f16 v44, v44, v45
    s_nop 1
    v_mov_b32_dpp v45, v44 row_ror:8 row_mask:0xf bank_mask:0xf
    v_pk_add_f16 v11, v44, v45
    ds_write_b32 v8, v11
KF_ISS0:
    s_cmp_lt_i32 s19, 0
    s_cbranch_scc1 KF_NXT0
    s_waitcnt lgkmcnt(0)
    buffer_load_dwordx4 v[44:47], v[16:17], s[44:47], 0 idxen offen sc1
    buffer_load_dwordx4 v[48:51], v[18:19], s[44:47], 0 idxen offen sc1
    buffer_load_dwordx4 v[52:55], v[20:21], s[44:47], 0 idxen offen sc1
    buffer_load_dwordx4 v[56:59], v[22:23], s[44:47], 0 idxen offen sc1
    buffer_load_dwordx4 v[60:63], v[24:25], s[44:47], 0 idxen offen sc1
    buffer_load_dwordx4 v[64:67], v[26:27], s[44:47], 0 idxen offen sc1
    buffer_load_dwordx4 v[68:71], v[28:29], s[44:47], 0 idxen offen sc1
    buffer_load_dwordx4 v[72:75], v[30:31], s[44:47], 0 idxen offen sc1
    buffer_load_dwordx4 v[76:79], v[32:33], s[44:47], 0 idxen offen sc1
    buffer_load_dwordx4 v[80:83], v[34:35], s[44:47], 0 idxen offen sc1
KF_NXT0:
    s_waitcnt vmcnt(10)
    s_cmp_lt_i32 s19, 0
    s_cbranch_scc0 KF_SV1
    s_waitcnt vmcnt(0)
KF_SV1:
    s_cmp_ge_u32 s13, s23
    s_cbranch_scc1 KF_PB1
    s_cmp_eq_u32 s23, 10
    s_cselect_b32 s13, 11, s23
    v_mov_b32 v11, s13
    ds_write_b32 v42, v11
KF_PB1:
    s_cmp_ge_u32 s23, 10
    s_cbranch_scc1 KF_ND1
    ds_read_b32 v11, v42 offset:16
    s_sub_u32 s16, s23, 3
    s_waitcnt lgkmcnt(0)
    v_cmp_gt_u32 vcc, s16, v11
    s_cbranch_vccnz KF_ND1
    s_add_u32 s23, s23, 1
    s_mov_b32 m0, s15
    s_add_u32 s18, s14, 4096
    buffer_load_dwordx4 v1, s[32:35], s14 offen offset:0 sc1 lds
    buffer_load_dwordx4 v1, s[32:35], s14 offen offset:1024 sc1 lds
    buffer_load_dwordx4 v1, s[32:35], s14 offen offset:2048 sc1 lds
    buffer_load_dwordx4 v1, s[32:35], s14 offen offset:3072 sc1 lds
    s_add_u32 m0, s15, 4096
    s_add_u32 s14, s14, 32768
    buffer_load_dwordx4 v1, s[32:35], s18 offen offset:0 sc1 lds
    buffer_load_dwordx4 v1, s[32:35], s18 offen offset:1024 sc1 lds
    buffer_load_dwordx4 v1, s[32:35], s18 offen offset:2048 sc1 lds
    buffer_load_dwordx4 v1, s[32:35], s18 offen offset:3072 sc1 lds
    s_add_u32 s15, s15, 32768
    s_and_b32 s15, s15, 0x1ffff
KF_ND1:
    s_mov_b32 s29, s25
    s_mov_b32 s30, s26
    s_cmp_gt_i32 s26, 0
    s_cbranch_scc1 KF_CONT1
    s_mov_b32 s25, -1
    s_cmp_ge_u32 s21, s22
    s_cbranch_scc1 KF_CONS1
    s_mov_b32 s25, s21
    v_readlane_b32 s26, v4, s21
    s_mul_i32 s16, s21, 356
    s_add_u32 s21, s21, 1
    v_add_u32 v10, s16, v15
    s_branch KF_RD1
KF_CONT1:
    v_add_u32 v10, 160, v10
KF_RD1:
    s_sub_i32 s26, s26, 160
    ds_read_u16 v128, v10 offset:160
    ds_read_u16 v130, v10 offset:176
    ds_read_u16 v132, v10 offset:192
    ds_read_u16 v134, v10 offset:208
    ds_read_u16 v136, v10 offset:224
    ds_read_u16 v138, v10 offset:240
    ds_read_u16 v140, v10 offset:256
    ds_read_u16 v142, v10 offset:272
    ds_read_u16 v144, v10 offset:288
    ds_read_u16 v146, v10 offset:304
KF_CONS1:
    s_cmp_lt_i32 s29, 0
    s_cbranch_scc1 KF_ISS1
    s_cmp_le_i32 s30, -32
    s_cbranch_scc1 KF_A81
    v_pk_add_f16 v84, v84, v116
    v_pk_add_f16 v85, v85, v117
    v_pk_add_f16 v86, v86, v118
    v_pk_add_f16 v87, v87, v119
    s_cmp_le_i32 s30, -16
    s_cbranch_scc1 KF_A81
    v_pk_add_f16 v88, v88, v120
    v_pk_add_f16 v89, v89, v121
    v_pk_add_f16 v90, v90, v122
    v_pk_add_f16 v91, v91, v123
KF_A81:
    v_pk_add_f16 v84, v84, v100
    v_pk_add_f16 v85, v85, v101
    v_pk_add_f16 v86, v86, v102
    v_pk_add_f16 v87, v87, v103
    v_pk_add_f16 v88, v88, v104
    v_pk_add_f16 v89, v89, v105
    v_pk_add_f16 v90, v90, v106
    v_pk_add_f16 v91, v91, v107
    v_pk_add_f16 v92, v92, v108
    v_pk_add_f16 v93, v93, v109
    v_pk_add_f16 v94, v94, v110
    v_pk_add_f16 v95, v95, v111
    v_pk_add_f16 v96, v96, v112
    v_pk_add_f16 v97, v97, v113
    v_pk_add_f16 v98, v98, v114
    v_pk_add_f16 v99, v99, v115
    v_pk_add_f16 v84, v84, v92
    v_pk_add_f16 v85, v85, v93
    v_pk_add_f16 v86, v86, v94
    v_pk_add_f16 v87, v87, v95
    v_pk_add_f16 v88, v88, v96
    v_pk_add_f16 v89, v89, v97
    v_pk_add_f16 v90, v90, v98
    v_pk_add_f16 v91, v91, v99
    v_pk_add_f16 v84, v84, v88
    v_pk_add_f16 v85, v85, v89
    v_pk_add_f16 v86, v86, v90
    v_pk_add_f16 v87, v87, v91
    s_max_i32 s16, s28, s30
    s_cmp_gt_i32 s16, 0
    s_cbranch_scc1 KF_MC1
KF_FIN1:
    s_lshl_b32 s29, s29, 7
    v_permlane32_swap_b32 v84, v86
    v_permlane32_swap_b32 v85, v87
    v_pk_add_f16 v84, v84, v86
    v_pk_add_f16 v85, v85, v87
    v_add_u32 v8, s29, v5
    s_nop 0
    v_permlane16_swap_b32 v84, v85
    v_pk_add_f16 v84, v84, v85
    s_nop 1
    v_mov_b32_dpp v85, v84 row_ror:8 row_mask:0xf bank_mask:0xf
    v_pk_add_f16 v11, v84, v85
    ds_write_b32 v8, v11
KF_ISS1:
    s_cmp_lt_i32 s25, 0
    s_cbranch_scc1 KF_NXT1
    s_waitcnt lgkmcnt(0)
    buffer_load_dwordx4 v[84:87], v[128:129], s[44:47], 0 idxen offen sc1
    buffer_load_dwordx4 v[88:91], v[130:131], s[44:47], 0 idxen offen sc1
    buffer_load_dwordx4 v[92:95], v[132:133], s[44:47], 0 idxen offen sc1
    buffer_load_dwordx4 v[96:99], v[134:135], s[44:47], 0 idxen offen sc1
    buffer_load_dwordx4 v[100:103], v[136:137], s[44:47], 0 idxen offen sc1
    buffer_load_dwordx4 v[104:107], v[138:139], s[44:47], 0 idxen offen sc1
    buffer_load_dwordx4 v[108:111], v[140:141], s[44:47], 0 idxen offen sc1
    buffer_load_dwordx4 v[112:115], v[142:143], s[44:47], 0 idxen offen sc1
    buffer_load_dwordx4 v[116:119], v[144:145], s[44:47], 0 idxen offen sc1
    buffer_load_dwordx4 v[120:123], v[146:147], s[44:47], 0 idxen offen sc1
KF_NXT1:
    s_and_b32 s16, s19, s25
    s_cmp_eq_u32 s16, -1
    s_cbranch_scc0 KF_PER
    s_cmp_eq_u32 s13, 11
    s_cbranch_scc1 KF_HDONE
KF_IDLE:
    s_sleep 4
    s_branch KF_PER
KF_MC0:
    s_cmp_eq_u32 s27, 0
    s_cbranch_scc1 KF_MD0
    v_pk_add_f16 v44, v44, v36
    v_pk_add_f16 v45, v45, v37
    v_pk_add_f16 v46, v46, v38
    v_pk_add_f16 v47, v47, v39
KF_MD0:
    s_mov_b32 s27, 0
    s_cmp_gt_i32 s30, 0
    s_cbranch_scc0 KF_FIN0
    s_mov_b32 s27, 1
    v_mov_b32 v36, v44
    v_mov_b32 v37, v45
    v_mov_b32 v38, v46
    v_mov_b32 v39, v47
    s_branch KF_ISS0
KF_MC1:
    s_cmp_eq_u32 s28, 0
    s_cbranch_scc1 KF_MD1
    v_pk_add_f16 v84, v84, v148
    v_pk_add_f16 v85, v85, v149
    v_pk_add_f16 v86, v86, v150
    v_pk_add_f16 v87, v87, v151
KF_MD1:
    s_mov_b32 s28, 0
    s_cmp_gt_i32 s30, 0
    s_cbranch_scc0 KF_FIN1
    s_mov_b32 s28, 1
    v_mov_b32 v148, v84
    v_mov_b32 v149, v85
    v_mov_b32 v150, v86
    v_mov_b32 v151, v87
    s_branch KF_ISS1
KF_HDONE:
    s_cmp_eq_u32 s31, 0
    s_cbranch_scc0 KF_SLOW
    s_setprio 3
    ds_read_b32 v16, v41 offset:0
    ds_read_b32 v17, v41 offset:256
    ds_read_b32 v18, v41 offset:512
    ds_read_b32 v19, v41 offset:768
    ds_read_b32 v20, v41 offset:1024
    s_waitcnt lgkmcnt(4)
    v_fma_mix_f32 v22, v16, v152, 0 op_sel:[0,0,0] op_sel_hi:[1,0,0]
    v_fma_mix_f32 v23, v16, v152, 0 op_sel:[1,0,0] op_sel_hi:[1,0,0]
    v_cvt_pk_bf16_f32 v16, v22, v23
    ds_write_b32 v41, v16 offset:0
    s_waitcnt lgkmcnt(4)
    v_fma_mix_f32 v22, v17, v153, 0 op_sel:[0,0,0] op_sel_hi:[1,0,0]
    v_fma_mix_f32 v23, v17, v153, 0 op_sel:[1,0,0] op_sel_hi:[1,0,0]
    v_cvt_pk_bf16_f32 v17, v22, v23
    ds_write_b32 v41, v17 offset:256
    s_waitcnt lgkmcnt(4)
    v_fma_mix_f32 v22, v18, v154, 0 op_sel:[0,0,0] op_sel_hi:[1,0,0]
    v_fma_mix_f32 v23, v18, v154, 0 op_sel:[1,0,0] op_sel_hi:[1,0,0]
    v_cvt_pk_bf16_f32 v18, v22, v23
    ds_write_b32 v41, v18 offset:512
    s_waitcnt lgkmcnt(4)
    v_fma_mix_f32 v22, v19, v155, 0 op_sel:[0,0,0] op_sel_hi:[1,0,0]
    v_fma_mix_f32 v23, v19, v155, 0 op_sel:[1,0,0] op_sel_hi:[1,0,0]
    v_cvt_pk_bf16_f32 v19, v22, v23
    ds_write_b32 v41, v19 offset:768
    s_waitcnt lgkmcnt(4)
    v_fma_mix_f32 v22, v20, v156, 0 op_sel:[0,0,0] op_sel_hi:[1,0,0]
    v_fma_mix_f32 v23, v20, v156, 0 op_sel:[1,0,0] op_sel_hi:[1,0,0]
    v_cvt_pk_bf16_f32 v20, v22, v23
    ds_write_b32 v41, v20 offset:1024
KF_FS:
    s_waitcnt vmcnt(0) lgkmcnt(0)
    ds_write_b32 v43, v13 offset:16
    v_mov_b32 v7, 132388
    s_mov_b64 exec, 1
    ds_add_rtn_u32 v4, v7, v13
    s_waitcnt lgkmcnt(0)
    v_cmp_eq_u32 vcc, 6, v4
    s_cbranch_vccz KF_NB
    global_store_dword v40, v13, s[4:5] offset:8 sc1
KF_NB:
    s_mov_b64 exec, -1
    s_cmp_ge_u32 s2, 250
    s_cbranch_scc0 KF_F2
    s_barrier
    s_endpgm
KF_F2:
    s_load_dwordx2 s[48:49], s[0:1], 0
    s_load_dwordx2 s[52:53], s[0:1], 72
    s_lshr_b32 s19, s9, 1
    s_and_b32 s20, s9, 1
    v_and_b32 v4, 31, v0
    v_lshrrev_b32 v5, 5, v0
    v_and_b32 v6, 7, v0
    v_add_u32 v7, 32, v6
    s_lshl_b32 s16, s8, 3
    v_add_u32 v6, s16, v6
    s_cmp_eq_u32 s19, 1
    s_cselect_b64 vcc, -1, 0
    s_cselect_b32 s21, 4, s8
    s_cselect_b32 s22, 8, 64
    v_cndmask_b32 v7, v4, v7, vcc
    v_cndmask_b32 v6, v4, v6, vcc
    v_lshl_add_u32 v6, v5, 5, v6
    v_lshlrev_b32 v6, 4, v6
    v_lshlrev_b32 v8, 4, v5
    v_lshl_add_u32 v8, v7, 7, v8
    v_add_u32 v9, 133120, v8
    s_mul_i32 s16, s2, 5120
    s_lshl_b32 s17, s20, 6
    s_add_u32 s16, s16, s17
    v_add_u32 v8, s16, v8
    v_cmp_le_u32 vcc, s22, v4
    v_mov_b32 v10, 0x80000000
    v_and_b32 v12, 3, v0
    v_cndmask_b32 v10, v8, v10, vcc
    v_lshlrev_b32 v12, 7, v12
    s_lshl_b32 s16, s7, 9
    s_add_u32 s16, s16, 0x700008
    v_add_u32 v14, s16, v12
    v_lshrrev_b32 v12, 5, v12
    s_mov_b32 s50, 0x138800
    s_mov_b32 s51, 0x20000
    s_mov_b32 s54, 0x138800
    s_mov_b32 s55, 0x20000
    s_lshl_b32 s16, s20, 12
    s_add_u32 s16, s16, 0x3b9000
    s_add_u32 s56, s4, s16
    s_addc_u32 s57, s5, 0
    s_add_u32 s58, s56, 8192
    s_addc_u32 s59, s57, 0
    s_mul_i32 s16, s7, 81920
    s_lshl_b32 s17, s21, 12
    s_add_u32 s16, s16, s17
    s_add_u32 s16, s16, 0x900000
    s_add_u32 s60, s4, s16
    s_addc_u32 s61, s5, 0
    s_add_u32 s16, s16, 20480
    s_add_u32 s62, s4, s16
    s_addc_u32 s63, s5, 0
    s_add_u32 s16, s16, 20480
    s_add_u32 s64, s4, s16
    s_addc_u32 s65, s5, 0
    s_add_u32 s16, s16, 20480
    s_add_u32 s66, s4, s16
    s_addc_u32 s67, s5, 0
    s_waitcnt lgkmcnt(0)
    buffer_load_dwordx4 v[80:83], v8, s[48:51], 0 offen offset:0
    buffer_load_dwordx4 v[84:87], v8, s[48:51], 0 offen offset:32
KF_WW:
    global_load_dword v11, v12, s[80:81] offset:16 sc1
    s_waitcnt vmcnt(0)
    v_cmp_eq_u32 vcc, 0, v11
    s_cbranch_vccz KF_WG
    s_sub_u32 s82, s82, 1
    s_cbranch_scc1 KF_WG
    s_sleep 12
    s_branch KF_WW
KF_WG:
    global_load_dwordx4 v[32:35], v1, s[56:57] offset:0 sc1
    global_load_dwordx4 v[36:39], v1, s[56:57] offset:1024 sc1
    global_load_dwordx4 v[40:43], v1, s[56:57] offset:2048 sc1
    global_load_dwordx4 v[44:47], v1, s[56:57] offset:3072 sc1
    global_load_dwordx4 v[16:19], v1, s[58:59] offset:0 sc1
    global_load_dwordx4 v[20:23], v1, s[58:59] offset:1024 sc1
    global_load_dwordx4 v[24:27], v1, s[58:59] offset:2048 sc1
    global_load_dwordx4 v[28:31], v1, s[58:59] offset:3072 sc1
    s_mov_b32 s16, 0xffff0000
    v_lshlrev_b32 v48, 16, v80
    v_and_b32 v49, s16, v80
    v_lshlrev_b32 v50, 16, v81
    v_and_b32 v51, s16, v81
    v_lshlrev_b32 v52, 16, v82
    v_and_b32 v53, s16, v82
    v_lshlrev_b32 v54, 16, v83
    v_and_b32 v55, s16, v83
    v_lshlrev_b32 v56, 16, v84
    v_and_b32 v57, s16, v84
    v_lshlrev_b32 v58, 16, v85
    v_and_b32 v59, s16, v85
    v_lshlrev_b32 v60, 16, v86
    v_and_b32 v61, s16, v86
    v_lshlrev_b32 v62, 16, v87
    v_and_b32 v63, s16, v87
KF_GW:
    ds_read_b32 v11, v3 offset:16
    s_waitcnt lgkmcnt(0)
    v_cmp_eq_u32 vcc, 0, v11
    s_cbranch_vccz KF_GG
    s_sleep 4
    s_branch KF_GW
KF_GG:
    ds_read_b128 v[64:67], v9 offset:0
    ds_read_b128 v[68:71], v9 offset:32
    ds_read_b128 v[72:75], v9 offset:64
    ds_read_b128 v[76:79], v9 offset:96
    s_waitcnt vmcnt(0) lgkmcnt(0)
    v_mfma_f32_32x32x16_bf16 v[48:63], v[32:35], v[64:67], v[48:63]
    v_mfma_f32_32x32x16_bf16 v[48:63], v[36:39], v[68:71], v[48:63]
    v_mfma_f32_32x32x16_bf16 v[48:63], v[40:43], v[72:75], v[48:63]
    v_mfma_f32_32x32x16_bf16 v[48:63], v[44:47], v[76:79], v[48:63]
    v_mov_b64 v[88:89], 0
    v_mov_b64 v[90:91], 0
    v_mov_b64 v[92:93], 0
    v_mov_b64 v[94:95], 0
    v_mov_b64 v[96:97], 0
    v_mov_b64 v[98:99], 0
    v_mov_b64 v[100:101], 0
    v_mov_b64 v[102:103], 0
    s_mov_b32 s23, 15
    s_cmp_eq_u32 s42, 0
    s_cselect_b32 s82, 0, 8388608
    s_setprio 0
    s_barrier
KF_OW:
    global_load_dword v11, v14, s[4:5] sc1
    s_sleep 16
    s_waitcnt vmcnt(0)
    v_cmp_eq_u32 vcc, 0, v11
    s_cbranch_vccz KF_OG
    s_sub_u32 s82, s82, 1
    s_cbranch_scc0 KF_OW
    s_mov_b32 s82, 0
KF_OG:
    global_load_dwordx4 v[104:107], v6, s[60:61] offset:0 sc1
    global_load_dwordx4 v[108:111], v6, s[60:61] offset:1024 sc1
    global_load_dwordx4 v[112:115], v6, s[60:61] offset:2048 sc1
    global_load_dwordx4 v[116:119], v6, s[60:61] offset:3072 sc1
    global_load_dwordx4 v[120:123], v6, s[62:63] offset:0 sc1
    global_load_dwordx4 v[124:127], v6, s[62:63] offset:1024 sc1
    global_load_dwordx4 v[128:131], v6, s[62:63] offset:2048 sc1
    global_load_dwordx4 v[132:135], v6, s[62:63] offset:3072 sc1
    global_load_dwordx4 v[136:139], v6, s[64:65] offset:0 sc1
    global_load_dwordx4 v[140:143], v6, s[64:65] offset:1024 sc1
    global_load_dwordx4 v[144:147], v6, s[64:65] offset:2048 sc1
    global_load_dwordx4 v[148:151], v6, s[64:65] offset:3072 sc1
    global_load_dwordx4 v[152:155], v6, s[66:67] offset:0 sc1
    global_load_dwordx4 v[156:159], v6, s[66:67] offset:1024 sc1
    global_load_dwordx4 v[160:163], v6, s[66:67] offset:2048 sc1
    global_load_dwordx4 v[164:167], v6, s[66:67] offset:3072 sc1
    s_waitcnt vmcnt(12)
    v_max3_u32 v12, v104, v105, v106
    v_max3_u32 v13, v107, v108, v109
    v_max3_u32 v14, v110, v111, v112
    v_max3_u32 v15, v113, v114, v115
    v_max3_u32 v12, v12, v116, v117
    v_max3_u32 v13, v13, v118, v119
    v_max3_u32 v12, v12, v14, v15
    v_max_u32 v12, v12, v13
    v_cmp_eq_u32 vcc, -1, v12
    s_cbranch_vccnz KF_Xa0
    s_bitset0_b32 s23, 0
    v_mfma_f32_32x32x16_bf16 v[88:103], v[16:19], v[104:107], v[88:103]
    v_mfma_f32_32x32x16_bf16 v[88:103], v[20:23], v[108:111], v[88:103]
    v_mfma_f32_32x32x16_bf16 v[88:103], v[24:27], v[112:115], v[88:103]
    v_mfma_f32_32x32x16_bf16 v[88:103], v[28:31], v[116:119], v[88:103]
KF_Xa0:
    s_waitcnt vmcnt(8)
    v_max3_u32 v12, v120, v121, v122
    v_max3_u32 v13, v123, v124, v125
    v_max3_u32 v14, v126, v127, v128
    v_max3_u32 v15, v129, v130, v131
    v_max3_u32 v12, v12, v132, v133
    v_max3_u32 v13, v13, v134, v135
    v_max3_u32 v12, v12, v14, v15
    v_max_u32 v12, v12, v13
    v_cmp_eq_u32 vcc, -1, v12
    s_cbranch_vccnz KF_Xa1
    s_bitset0_b32 s23, 1
    v_mfma_f32_32x32x16_bf16 v[88:103], v[16:19], v[120:123], v[88:103]
    v_mfma_f32_32x32x16_bf16 v[88:103], v[20:23], v[124:127], v[88:103]
    v_mfma_f32_32x32x16_bf16 v[88:103], v[24:27], v[128:131], v[88:103]
    v_mfma_f32_32x32x16_bf16 v[88:103], v[28:31], v[132:135], v[88:103]
KF_Xa1:
    s_waitcnt vmcnt(4)
    v_max3_u32 v12, v136, v137, v138
    v_max3_u32 v13, v139, v140, v141
    v_max3_u32 v14, v142, v143, v144
    v_max3_u32 v15, v145, v146, v147
    v_max3_u32 v12, v12, v148, v149
    v_max3_u32 v13, v13, v150, v151
    v_max3_u32 v12, v12, v14, v15
    v_max_u32 v12, v12, v13
    v_cmp_eq_u32 vcc, -1, v12
    s_cbranch_vccnz KF_Xa2
    s_bitset0_b32 s23, 2
    v_mfma_f32_32x32x16_bf16 v[88:103], v[16:19], v[136:139], v[88:103]
    v_mfma_f32_32x32x16_bf16 v[88:103], v[20:23], v[140:143], v[88:103]
    v_mfma_f32_32x32x16_bf16 v[88:103], v[24:27], v[144:147], v[88:103]
    v_mfma_f32_32x32x16_bf16 v[88:103], v[28:31], v[148:151], v[88:103]
KF_Xa2:
    s_waitcnt vmcnt(0)
    v_max3_u32 v12, v152, v153, v154
    v_max3_u32 v13, v155, v156, v157
    v_max3_u32 v14, v158, v159, v160
    v_max3_u32 v15, v161, v162, v163
    v_max3_u32 v12, v12, v164, v165
    v_max3_u32 v13, v13, v166, v167
    v_max3_u32 v12, v12, v14, v15
    v_max_u32 v12, v12, v13
    v_cmp_eq_u32 vcc, -1, v12
    s_cbranch_vccnz KF_Xa3
    s_bitset0_b32 s23, 3
    v_mfma_f32_32x32x16_bf16 v[88:103], v[16:19], v[152:155], v[88:103]
    v_mfma_f32_32x32x16_bf16 v[88:103], v[20:23], v[156:159], v[88:103]
    v_mfma_f32_32x32x16_bf16 v[88:103], v[24:27], v[160:163], v[88:103]
    v_mfma_f32_32x32x16_bf16 v[88:103], v[28:31], v[164:167], v[88:103]
KF_Xa3:
    s_cmp_lg_u32 s23, 0
    s_cbranch_scc1 KF_RT
KF_RE:
    v_and_b32 v12, s16, v119
    v_and_b32 v13, s16, v135
    v_and_b32 v14, s16, v151
    v_and_b32 v15, s16, v167
    v_add_f32 v12, v12, v13
    v_add_f32 v14, v14, v15
    v_add_f32 v13, v12, v14
    v_add_f32 v12, v12, v14
    s_mov_b32 s17, 0x3c000000
    s_nop 0
    v_permlane32_swap_b32 v12, v13
    v_subrev_u32 v14, 0x21800000, v13
    v_cmp_le_u32 vcc, s17, v14
    s_cbranch_vccnz KF_FB
KF_FT:
    v_rcp_f32 v12, v13
    s_nop 2
    v_pk_fma_f32 v[88:89], v[88:89], v[12:13], v[48:49] op_sel_hi:[1,0,1]
    v_pk_fma_f32 v[90:91], v[90:91], v[12:13], v[50:51] op_sel_hi:[1,0,1]
    v_pk_fma_f32 v[92:93], v[92:93], v[12:13], v[52:53] op_sel_hi:[1,0,1]
    v_pk_fma_f32 v[94:95], v[94:95], v[12:13], v[54:55] op_sel_hi:[1,0,1]
    v_pk_fma_f32 v[96:97], v[96:97], v[12:13], v[56:57] op_sel_hi:[1,0,1]
    v_pk_fma_f32 v[98:99], v[98:99], v[12:13], v[58:59] op_sel_hi:[1,0,1]
    v_pk_fma_f32 v[100:101], v[100:101], v[12:13], v[60:61] op_sel_hi:[1,0,1]
    v_pk_fma_f32 v[102:103], v[102:103], v[12:13], v[62:63] op_sel_hi:[1,0,1]
    v_cvt_pk_bf16_f32 v80, v88, v89
    v_cvt_pk_bf16_f32 v81, v90, v91
    v_cvt_pk_bf16_f32 v82, v92, v93
    v_cvt_pk_bf16_f32 v83, v94, v95
    buffer_store_dwordx4 v[80:83], v10, s[52:55], 0 offen
    v_cvt_pk_bf16_f32 v84, v96, v97
    v_cvt_pk_bf16_f32 v85, v98, v99
    v_cvt_pk_bf16_f32 v86, v100, v101
    v_cvt_pk_bf16_f32 v87, v102, v103
    buffer_store_dwordx4 v[84:87], v10, s[52:55], 0 offen offset:32
    s_endpgm
KF_RT:
    s_sub_u32 s82, s82, 1
    s_cbranch_scc1 KF_RE
    s_sleep 2
    s_bitcmp1_b32 s23, 0
    s_cbranch_scc0 KF_RL0
    global_load_dwordx4 v[104:107], v6, s[60:61] offset:0 sc1
    global_load_dwordx4 v[108:111], v6, s[60:61] offset:1024 sc1
    global_load_dwordx4 v[112:115], v6, s[60:61] offset:2048 sc1
    global_load_dwordx4 v[116:119], v6, s[60:61] offset:3072 sc1
KF_RL0:
    s_bitcmp1_b32 s23, 1
    s_cbranch_scc0 KF_RL1
    global_load_dwordx4 v[120:123], v6, s[62:63] offset:0 sc1
    global_load_dwordx4 v[124:127], v6, s[62:63] offset:1024 sc1
    global_load_dwordx4 v[128:131], v6, s[62:63] offset:2048 sc1
    global_load_dwordx4 v[132:135], v6, s[62:63] offset:3072 sc1
KF_RL1:
    s_bitcmp1_b32 s23, 2
    s_cbranch_scc0 KF_RL2
    global_load_dwordx4 v[136:139], v6, s[64:65] offset:0 sc1
    global_load_dwordx4 v[140:143], v6, s[64:65] offset:1024 sc1
    global_load_dwordx4 v[144:147], v6, s[64:65] offset:2048 sc1
    global_load_dwordx4 v[148:151], v6, s[64:65] offset:3072 sc1
KF_RL2:
    s_bitcmp1_b32 s23, 3
    s_cbranch_scc0 KF_RL3
    global_load_dwordx4 v[152:155], v6, s[66:67] offset:0 sc1
    global_load_dwordx4 v[156:159], v6, s[66:67] offset:1024 sc1
    global_load_dwordx4 v[160:163], v6, s[66:67] offset:2048 sc1
    global_load_dwordx4 v[164:167], v6, s[66:67] offset:3072 sc1
KF_RL3:
    s_waitcnt vmcnt(0)
    s_bitcmp1_b32 s23, 0
    s_cbranch_scc0 KF_Xb0
    v_max3_u32 v12, v104, v105, v106
    v_max3_u32 v13, v107, v108, v109
    v_max3_u32 v14, v110, v111, v112
    v_max3_u32 v15, v113, v114, v115
    v_max3_u32 v12, v12, v116, v117
    v_max3_u32 v13, v13, v118, v119
    v_max3_u32 v12, v12, v14, v15
    v_max_u32 v12, v12, v13
    v_cmp_eq_u32 vcc, -1, v12
    s_cbranch_vccnz KF_Xb0
    s_bitset0_b32 s23, 0
    v_mfma_f32_32x32x16_bf16 v[88:103], v[16:19], v[104:107], v[88:103]
    v_mfma_f32_32x32x16_bf16 v[88:103], v[20:23], v[108:111], v[88:103]
    v_mfma_f32_32x32x16_bf16 v[88:103], v[24:27], v[112:115], v[88:103]
    v_mfma_f32_32x32x16_bf16 v[88:103], v[28:31], v[116:119], v[88:103]
KF_Xb0:
    s_bitcmp1_b32 s23, 1
    s_cbranch_scc0 KF_Xb1
    v_max3_u32 v12, v120, v121, v122
    v_max3_u32 v13, v123, v124, v125
    v_max3_u32 v14, v126, v127, v128
    v_max3_u32 v15, v129, v130, v131
    v_max3_u32 v12, v12, v132, v133
    v_max3_u32 v13, v13, v134, v135
    v_max3_u32 v12, v12, v14, v15
    v_max_u32 v12, v12, v13
    v_cmp_eq_u32 vcc, -1, v12
    s_cbranch_vccnz KF_Xb1
    s_bitset0_b32 s23, 1
    v_mfma_f32_32x32x16_bf16 v[88:103], v[16:19], v[120:123], v[88:103]
    v_mfma_f32_32x32x16_bf16 v[88:103], v[20:23], v[124:127], v[88:103]
    v_mfma_f32_32x32x16_bf16 v[88:103], v[24:27], v[128:131], v[88:103]
    v_mfma_f32_32x32x16_bf16 v[88:103], v[28:31], v[132:135], v[88:103]
KF_Xb1:
    s_bitcmp1_b32 s23, 2
    s_cbranch_scc0 KF_Xb2
    v_max3_u32 v12, v136, v137, v138
    v_max3_u32 v13, v139, v140, v141
    v_max3_u32 v14, v142, v143, v144
    v_max3_u32 v15, v145, v146, v147
    v_max3_u32 v12, v12, v148, v149
    v_max3_u32 v13, v13, v150, v151
    v_max3_u32 v12, v12, v14, v15
    v_max_u32 v12, v12, v13
    v_cmp_eq_u32 vcc, -1, v12
    s_cbranch_vccnz KF_Xb2
    s_bitset0_b32 s23, 2
    v_mfma_f32_32x32x16_bf16 v[88:103], v[16:19], v[136:139], v[88:103]
    v_mfma_f32_32x32x16_bf16 v[88:103], v[20:23], v[140:143], v[88:103]
    v_mfma_f32_32x32x16_bf16 v[88:103], v[24:27], v[144:147], v[88:103]
    v_mfma_f32_32x32x16_bf16 v[88:103], v[28:31], v[148:151], v[88:103]
KF_Xb2:
    s_bitcmp1_b32 s23, 3
    s_cbranch_scc0 KF_Xb3
    v_max3_u32 v12, v152, v153, v154
    v_max3_u32 v13, v155, v156, v157
    v_max3_u32 v14, v158, v159, v160
    v_max3_u32 v15, v161, v162, v163
    v_max3_u32 v12, v12, v164, v165
    v_max3_u32 v13, v13, v166, v167
    v_max3_u32 v12, v12, v14, v15
    v_max_u32 v12, v12, v13
    v_cmp_eq_u32 vcc, -1, v12
    s_cbranch_vccnz KF_Xb3
    s_bitset0_b32 s23, 3
    v_mfma_f32_32x32x16_bf16 v[88:103], v[16:19], v[152:155], v[88:103]
    v_mfma_f32_32x32x16_bf16 v[88:103], v[20:23], v[156:159], v[88:103]
    v_mfma_f32_32x32x16_bf16 v[88:103], v[24:27], v[160:163], v[88:103]
    v_mfma_f32_32x32x16_bf16 v[88:103], v[28:31], v[164:167], v[88:103]
KF_Xb3:
    s_cmp_lg_u32 s23, 0
    s_cbranch_scc1 KF_RT
    s_branch KF_RE
KF_FB:
    v_and_b32 v12, 31, v0
    v_lshrrev_b32 v13, 5, v0
    v_lshlrev_b32 v4, 2, v13
    v_xor_b32 v4, v4, v12
    v_lshlrev_b32 v4, 4, v4
    v_lshl_add_u32 v4, v13, 9, v4
    v_bfe_u32 v12, v0, 4, 1
    v_bfe_u32 v7, v0, 1, 1
    v_lshl_or_b32 v12, v12, 1, v7
    v_bfe_u32 v7, v0, 2, 2
    v_lshl_or_b32 v7, v13, 2, v7
    v_lshlrev_b32 v14, 2, v12
    v_xor_b32 v7, v7, v14
    v_lshlrev_b32 v7, 4, v7
    v_lshl_add_u32 v7, v12, 9, v7
    v_and_b32 v14, 1, v0
    v_lshl_add_u32 v7, v14, 3, v7
    s_lshl_b32 s17, s9, 12
    s_add_u32 s17, s17, 32768
    v_add_u32 v4, s17, v4
    v_xor_b32 v5, 128, v4
    v_add_u32 v8, s17, v7
    v_xor_b32 v9, 128, v8
    v_add_u32 v7, s17, v1
    s_lshl_b32 s18, s19, 12
    v_add_u32 v6, s18, v6
    s_lshl_b32 s18, s19, 2
    s_add_u32 s18, s18, 132400
    v_mov_b32 v12, s18
KF_FQ:
    s_sleep 2
    ds_read_b32 v13, v12
    s_waitcnt lgkmcnt(0)
    v_cmp_eq_u32 vcc, 0, v13
    s_cbranch_vccnz KF_FQ
    ds_read_b128 v[104:107], v6 offset:49152
    ds_read_b128 v[108:111], v6 offset:50176
    ds_read_b128 v[112:115], v6 offset:51200
    ds_read_b128 v[116:119], v6 offset:52224
    v_mov_b64 v[32:33], 0
    v_mov_b64 v[34:35], 0
    v_mov_b64 v[36:37], 0
    v_mov_b64 v[38:39], 0
    v_mov_b64 v[40:41], 0
    v_mov_b64 v[42:43], 0
    v_mov_b64 v[44:45], 0
    v_mov_b64 v[46:47], 0
    v_mov_b64 v[88:89], 0
    v_mov_b64 v[90:91], 0
    v_mov_b64 v[92:93], 0
    v_mov_b64 v[94:95], 0
    v_mov_b64 v[96:97], 0
    v_mov_b64 v[98:99], 0
    v_mov_b64 v[100:101], 0
    v_mov_b64 v[102:103], 0
    v_mov_b32 v11, 0xff7fffff
    s_mov_b32 s17, 0
KF_FL:
    buffer_load_dwordx4 v[152:155], v1, s[32:35], s17 offen offset:0 sc1
    buffer_load_dwordx4 v[156:159], v1, s[32:35], s17 offen offset:1024 sc1
    buffer_load_dwordx4 v[160:163], v1, s[32:35], s17 offen offset:2048 sc1
    buffer_load_dwordx4 v[164:167], v1, s[32:35], s17 offen offset:3072 sc1
    s_waitcnt vmcnt(0)
    ds_write_b128 v7, v[152:155] offset:0
    ds_write_b128 v7, v[156:159] offset:1024
    ds_write_b128 v7, v[160:163] offset:2048
    ds_write_b128 v7, v[164:167] offset:3072
    ds_read_b128 v[120:123], v4 offset:0
    ds_read_b128 v[124:127], v5 offset:1024
    ds_read_b128 v[128:131], v4 offset:2048
    ds_read_b128 v[132:135], v5 offset:3072
    ds_read_b64_tr_b16 v[136:137], v8 offset:0
    ds_read_b64_tr_b16 v[138:139], v9 offset:0
    ds_read_b64_tr_b16 v[140:141], v8 offset:2048
    ds_read_b64_tr_b16 v[142:143], v9 offset:2048
    ds_read_b64_tr_b16 v[144:145], v8 offset:256
    ds_read_b64_tr_b16 v[146:147], v9 offset:256
    ds_read_b64_tr_b16 v[148:149], v8 offset:2304
    ds_read_b64_tr_b16 v[150:151], v9 offset:2304
    s_waitcnt lgkmcnt(0)
    v_mfma_f32_32x32x16_bf16 v[64:79], v[120:123], v[104:107], 0
    v_mfma_f32_32x32x16_bf16 v[64:79], v[124:127], v[108:111], v[64:79]
    v_mfma_f32_32x32x16_bf16 v[64:79], v[128:131], v[112:115], v[64:79]
    v_mfma_f32_32x32x16_bf16 v[64:79], v[132:135], v[116:119], v[64:79]
    s_nop 15
    s_cmp_lg_u32 s17, 0x138000
    s_cbranch_scc1 KF_FM
    v_mov_b32 v72, 0xff7fffff
    v_mov_b32 v73, 0xff7fffff
    v_mov_b32 v74, 0xff7fffff
    v_mov_b32 v75, 0xff7fffff
    v_mov_b32 v76, 0xff7fffff
    v_mov_b32 v77, 0xff7fffff
    v_mov_b32 v78, 0xff7fffff
    v_mov_b32 v79, 0xff7fffff
KF_FM:
    v_max3_f32 v12, v11, v64, v65
    v_max3_f32 v12, v12, v66, v67
    v_max3_f32 v12, v12, v68, v69
    v_max3_f32 v12, v12, v70, v71
    v_max3_f32 v12, v12, v72, v73
    v_max3_f32 v12, v12, v74, v75
    v_max3_f32 v12, v12, v76, v77
    v_max3_f32 v12, v12, v78, v79
    v_mov_b32 v13, v12
    s_nop 1
    v_permlane32_swap_b32 v12, v13
    v_max_f32 v13, v12, v13
    v_sub_f32 v14, v11, v13
    v_exp_f32 v14, v14
    v_mov_b32 v11, v13
    v_sub_f32 v64, v64, v13
    v_sub_f32 v65, v65, v13
    v_sub_f32 v66, v66, v13
    v_sub_f32 v67, v67, v13
    v_sub_f32 v68, v68, v13
    v_sub_f32 v69, v69, v13
    v_sub_f32 v70, v70, v13
    v_sub_f32 v71, v71, v13
    v_sub_f32 v72, v72, v13
    v_sub_f32 v73, v73, v13
    v_sub_f32 v74, v74, v13
    v_sub_f32 v75, v75, v13
    v_sub_f32 v76, v76, v13
    v_sub_f32 v77, v77, v13
    v_sub_f32 v78, v78, v13
    v_sub_f32 v79, v79, v13
    v_pk_mul_f32 v[32:33], v[32:33], v[14:15] op_sel_hi:[1,0]
    v_pk_mul_f32 v[34:35], v[34:35], v[14:15] op_sel_hi:[1,0]
    v_pk_mul_f32 v[36:37], v[36:37], v[14:15] op_sel_hi:[1,0]
    v_pk_mul_f32 v[38:39], v[38:39], v[14:15] op_sel_hi:[1,0]
    v_pk_mul_f32 v[40:41], v[40:41], v[14:15] op_sel_hi:[1,0]
    v_pk_mul_f32 v[42:43], v[42:43], v[14:15] op_sel_hi:[1,0]
    v_pk_mul_f32 v[44:45], v[44:45], v[14:15] op_sel_hi:[1,0]
    v_pk_mul_f32 v[46:47], v[46:47], v[14:15] op_sel_hi:[1,0]
    v_pk_mul_f32 v[88:89], v[88:89], v[14:15] op_sel_hi:[1,0]
    v_pk_mul_f32 v[90:91], v[90:91], v[14:15] op_sel_hi:[1,0]
    v_pk_mul_f32 v[92:93], v[92:93], v[14:15] op_sel_hi:[1,0]
    v_pk_mul_f32 v[94:95], v[94:95], v[14:15] op_sel_hi:[1,0]
    v_pk_mul_f32 v[96:97], v[96:97], v[14:15] op_sel_hi:[1,0]
    v_pk_mul_f32 v[98:99], v[98:99], v[14:15] op_sel_hi:[1,0]
    v_pk_mul_f32 v[100:101], v[100:101], v[14:15] op_sel_hi:[1,0]
    v_pk_mul_f32 v[102:103], v[102:103], v[14:15] op_sel_hi:[1,0]
    v_exp_f32 v64, v64
    v_exp_f32 v65, v65
    v_exp_f32 v66, v66
    v_exp_f32 v67, v67
    v_exp_f32 v68, v68
    v_exp_f32 v69, v69
    v_exp_f32 v70, v70
    v_exp_f32 v71, v71
    v_exp_f32 v72, v72
    v_exp_f32 v73, v73
    v_exp_f32 v74, v74
    v_exp_f32 v75, v75
    v_exp_f32 v76, v76
    v_exp_f32 v77, v77
    v_exp_f32 v78, v78
    v_exp_f32 v79, v79
    s_nop 0
    v_cvt_pk_bf16_f32 v64, v64, v65
    v_cvt_pk_bf16_f32 v65, v66, v67
    v_cvt_pk_bf16_f32 v66, v68, v69
    v_cvt_pk_bf16_f32 v67, v70, v71
    v_cvt_pk_bf16_f32 v72, v72, v73
    v_cvt_pk_bf16_f32 v73, v74, v75
    v_cvt_pk_bf16_f32 v74, v76, v77
    v_cvt_pk_bf16_f32 v75, v78, v79
    s_nop 1
    v_mfma_f32_32x32x16_bf16 v[32:47], v[136:139], v[64:67], v[32:47]
    v_mfma_f32_32x32x16_bf16 v[88:103], v[140:143], v[64:67], v[88:103]
    v_mfma_f32_32x32x16_bf16 v[32:47], v[144:147], v[72:75], v[32:47]
    v_mfma_f32_32x32x16_bf16 v[88:103], v[148:151], v[72:75], v[88:103]
    s_add_u32 s17, s17, 4096
    s_cmp_le_u32 s17, 0x138000
    s_cbranch_scc1 KF_FL
    s_nop 15
    v_mov_b32 v12, v103
    v_mov_b32 v13, v103
    v_cvt_pk_bf16_f32 v104, v32, v33
    v_cvt_pk_bf16_f32 v105, v34, v35
    v_cvt_pk_bf16_f32 v106, v36, v37
    v_cvt_pk_bf16_f32 v107, v38, v39
    v_cvt_pk_bf16_f32 v108, v40, v41
    v_cvt_pk_bf16_f32 v109, v42, v43
    v_cvt_pk_bf16_f32 v110, v44, v45
    v_cvt_pk_bf16_f32 v111, v46, v47
    v_cvt_pk_bf16_f32 v112, v88, v89
    v_cvt_pk_bf16_f32 v113, v90, v91
    v_cvt_pk_bf16_f32 v114, v92, v93
    v_cvt_pk_bf16_f32 v115, v94, v95
    v_cvt_pk_bf16_f32 v116, v96, v97
    v_cvt_pk_bf16_f32 v117, v98, v99
    v_cvt_pk_bf16_f32 v118, v100, v101
    v_cvt_pk_bf16_f32 v119, v102, v103
    v_permlane32_swap_b32 v12, v13
    s_nop 1
    v_mfma_f32_32x32x16_bf16 v[88:103], v[16:19], v[104:107], 0
    v_mfma_f32_32x32x16_bf16 v[88:103], v[20:23], v[108:111], v[88:103]
    v_mfma_f32_32x32x16_bf16 v[88:103], v[24:27], v[112:115], v[88:103]
    v_mfma_f32_32x32x16_bf16 v[88:103], v[28:31], v[116:119], v[88:103]
    s_nop 15
    s_branch KF_FT
KF_SLOW:
    s_mul_i32 s21, s9, 10
    s_mul_i32 s22, s9, 2560
    v_lshlrev_b32 v6, 2, v0
    v_add_u32 v6, 149600, v6
    v_add_u32 v7, s22, v6
    v_mov_b32 v8, 0
    v_lshlrev_b32 v9, 1, v0
    v_add_u32 v10, s24, v9
    buffer_load_ushort v41, v10, s[68:71], 0 offen
    ds_write_b32 v7, v8 offset:0
    ds_write_b32 v7, v8 offset:256
    ds_write_b32 v7, v8 offset:512
    ds_write_b32 v7, v8 offset:768
    ds_write_b32 v7, v8 offset:1024
    ds_write_b32 v7, v8 offset:1280
    ds_write_b32 v7, v8 offset:1536
    ds_write_b32 v7, v8 offset:1792
    ds_write_b32 v7, v8 offset:2048
    ds_write_b32 v7, v8 offset:2304
    s_add_u32 s44, s4, 0x280000
    s_addc_u32 s45, s5, 0
    s_mov_b32 s46, 0x138800
    s_mov_b32 s47, 0x20000
    s_mov_b32 s25, 0
KF_SP:
    s_mul_i32 s28, s25, 11264
    s_add_u32 s26, s28, s17
    v_mov_b32 v10, s26
    buffer_load_dword v10, v10, s[40:43], 0 offen sc1
    s_waitcnt vmcnt(0)
    v_readfirstlane_b32 s27, v10
    s_and_b32 s29, s27, 0xffff
    s_add_u32 s28, s28, s29
    s_lshr_b32 s29, s27, 16
    s_add_u32 s29, s29, s28
KF_SE:
    s_cmp_ge_u32 s28, s29
    s_cbranch_scc1 KF_SPN
    v_mov_b32 v10, s28
    buffer_load_dword v10, v10, s[40:43], 0 offen sc1
    s_add_u32 s28, s28, 4
    s_waitcnt vmcnt(0)
    v_readfirstlane_b32 s27, v10
    s_lshr_b32 s30, s27, 18
    s_sub_u32 s31, s30, s21
    s_cmp_ge_u32 s31, 10
    s_cbranch_scc1 KF_SE
    s_and_b32 s27, s27, 0xffff
    s_lshl_b32 s27, s27, 7
    v_add_u32 v12, s27, v9
    buffer_load_ushort v10, v12, s[44:47], 0 offen sc1
    s_lshl_b32 s30, s30, 8
    v_add_u32 v11, s30, v6
    ds_read_b32 v14, v11
    s_waitcnt vmcnt(0) lgkmcnt(0)
    v_cvt_f32_f16 v10, v10
    v_add_f32 v10, v10, v14
    ds_write_b32 v11, v10
    s_branch KF_SE
KF_SPN:
    s_add_u32 s25, s25, 1
    s_cmp_lt_u32 s25, 250
    s_cbranch_scc1 KF_SP
    s_waitcnt lgkmcnt(0)
    s_lshr_b32 s22, s22, 1
    s_add_u32 s22, s22, 133120
    v_add_u32 v8, s22, v9
    ds_read_b32 v16, v7 offset:0
    ds_read_b32 v17, v7 offset:256
    ds_read_b32 v18, v7 offset:512
    ds_read_b32 v19, v7 offset:768
    ds_read_b32 v20, v7 offset:1024
    ds_read_b32 v21, v7 offset:1280
    ds_read_b32 v22, v7 offset:1536
    ds_read_b32 v23, v7 offset:1792
    ds_read_b32 v24, v7 offset:2048
    ds_read_b32 v25, v7 offset:2304
    s_waitcnt lgkmcnt(0)
    v_readlane_b32 s16, v41, s21
    s_add_u32 s21, s21, 1
    s_lshl_b32 s16, s16, 16
    s_nop 1
    v_mul_f32 v16, s16, v16
    v_cvt_pk_bf16_f32 v16, v16, v16
    ds_write_b16 v8, v16 offset:0
    v_readlane_b32 s16, v41, s21
    s_add_u32 s21, s21, 1
    s_lshl_b32 s16, s16, 16
    s_nop 1
    v_mul_f32 v17, s16, v17
    v_cvt_pk_bf16_f32 v17, v17, v17
    ds_write_b16 v8, v17 offset:128
    v_readlane_b32 s16, v41, s21
    s_add_u32 s21, s21, 1
    s_lshl_b32 s16, s16, 16
    s_nop 1
    v_mul_f32 v18, s16, v18
    v_cvt_pk_bf16_f32 v18, v18, v18
    ds_write_b16 v8, v18 offset:256
    v_readlane_b32 s16, v41, s21
    s_add_u32 s21, s21, 1
    s_lshl_b32 s16, s16, 16
    s_nop 1
    v_mul_f32 v19, s16, v19
    v_cvt_pk_bf16_f32 v19, v19, v19
    ds_write_b16 v8, v19 offset:384
    v_readlane_b32 s16, v41, s21
    s_add_u32 s21, s21, 1
    s_lshl_b32 s16, s16, 16
    s_nop 1
    v_mul_f32 v20, s16, v20
    v_cvt_pk_bf16_f32 v20, v20, v20
    ds_write_b16 v8, v20 offset:512
    v_readlane_b32 s16, v41, s21
    s_add_u32 s21, s21, 1
    s_lshl_b32 s16, s16, 16
    s_nop 1
    v_mul_f32 v21, s16, v21
    v_cvt_pk_bf16_f32 v21, v21, v21
    ds_write_b16 v8, v21 offset:640
    v_readlane_b32 s16, v41, s21
    s_add_u32 s21, s21, 1
    s_lshl_b32 s16, s16, 16
    s_nop 1
    v_mul_f32 v22, s16, v22
    v_cvt_pk_bf16_f32 v22, v22, v22
    ds_write_b16 v8, v22 offset:768
    v_readlane_b32 s16, v41, s21
    s_add_u32 s21, s21, 1
    s_lshl_b32 s16, s16, 16
    s_nop 1
    v_mul_f32 v23, s16, v23
    v_cvt_pk_bf16_f32 v23, v23, v23
    ds_write_b16 v8, v23 offset:896
    v_readlane_b32 s16, v41, s21
    s_add_u32 s21, s21, 1
    s_lshl_b32 s16, s16, 16
    s_nop 1
    v_mul_f32 v24, s16, v24
    v_cvt_pk_bf16_f32 v24, v24, v24
    ds_write_b16 v8, v24 offset:1024
    v_readlane_b32 s16, v41, s21
    s_add_u32 s21, s21, 1
    s_lshl_b32 s16, s16, 16
    s_nop 1
    v_mul_f32 v25, s16, v25
    v_cvt_pk_bf16_f32 v25, v25, v25
    ds_write_b16 v8, v25 offset:1152
    s_branch KF_FS
KF_AUX:
    s_cmp_ge_u32 s6, 8
    s_cbranch_scc1 KF_END
    s_lshl_b32 s11, s6, 13
    s_add_u32 s11, s11, 0x700000
    v_lshl_add_u32 v1, v9, 7, s11
    v_mov_b64 v[2:3], 0
    v_mov_b64 v[4:5], 0
    s_lshl_b32 s10, s6, 2
    v_mov_b32 v6, s10
    v_mov_b32 v13, 1
    s_sub_u32 s9, s6, 4
    s_waitcnt lgkmcnt(0)
    s_mov_b32 s4, s58
    s_mov_b32 s5, s59
    s_cbranch_scc0 KF_WT
    global_store_dwordx4 v1, v[2:5], s[4:5] sc1
    global_load_dword v20, v2, s[56:57] offset:128 sc1
    s_mov_b64 exec, 1
    s_waitcnt vmcnt(1)
    global_store_dword v6, v13, s[56:57] sc1
    s_endpgm
KF_WT:
    v_mov_b32 v0, v9
    v_lshlrev_b32 v1, 4, v9
    v_and_b32 v7, 31, v0
    v_lshrrev_b32 v8, 5, v0
    v_and_b32 v9, 0x13, v7
    v_and_b32 v10, 4, v7
    v_lshl_or_b32 v9, v10, 1, v9
    v_and_b32 v10, 8, v7
    v_lshrrev_b32 v10, 1, v10
    v_or_b32 v9, v9, v10
    v_lshlrev_b32 v10, 4, v8
    v_add_u32 v11, 8064, v10
    s_cmp_ge_u32 s9, 2
    s_cselect_b32 s60, s50, s44
    s_cselect_b32 s61, s51, s45
    s_cselect_b32 s62, -1, 0
    s_cselect_b64 vcc, -1, 0
    s_and_b32 s63, s9, 1
    v_cndmask_b32 v7, v9, v7, vcc
    v_lshl_add_u32 v7, v7, 7, v10
    v_add_u32 v15, 4096, v7
    s_lshl_b32 s63, s63, 6
    v_lshlrev_b32 v8, 10, v8
    v_lshl_add_u32 v8, v9, 1, v8
    v_add_u32 v8, s63, v8
    v_add_u32 v9, 4096, v8
    global_load_ushort v108, v8, s[52:53] offset:0
    global_load_ushort v109, v8, s[52:53] offset:128
    global_load_ushort v110, v8, s[52:53] offset:256
    global_load_ushort v111, v8, s[52:53] offset:384
    global_load_ushort v112, v8, s[52:53] offset:512
    global_load_ushort v113, v8, s[52:53] offset:640
    global_load_ushort v114, v8, s[52:53] offset:768
    global_load_ushort v115, v8, s[52:53] offset:896
    global_load_ushort v116, v8, s[52:53] offset:2048
    global_load_ushort v117, v8, s[52:53] offset:2176
    global_load_ushort v118, v8, s[52:53] offset:2304
    global_load_ushort v119, v8, s[52:53] offset:2432
    global_load_ushort v120, v8, s[52:53] offset:2560
    global_load_ushort v121, v8, s[52:53] offset:2688
    global_load_ushort v122, v8, s[52:53] offset:2816
    global_load_ushort v123, v8, s[52:53] offset:2944
    global_load_ushort v124, v9, s[52:53] offset:0
    global_load_ushort v125, v9, s[52:53] offset:128
    global_load_ushort v126, v9, s[52:53] offset:256
    global_load_ushort v127, v9, s[52:53] offset:384
    global_load_ushort v128, v9, s[52:53] offset:512
    global_load_ushort v129, v9, s[52:53] offset:640
    global_load_ushort v130, v9, s[52:53] offset:768
    global_load_ushort v131, v9, s[52:53] offset:896
    global_load_ushort v132, v9, s[52:53] offset:2048
    global_load_ushort v133, v9, s[52:53] offset:2176
    global_load_ushort v134, v9, s[52:53] offset:2304
    global_load_ushort v135, v9, s[52:53] offset:2432
    global_load_ushort v136, v9, s[52:53] offset:2560
    global_load_ushort v137, v9, s[52:53] offset:2688
    global_load_ushort v138, v9, s[52:53] offset:2816
    global_load_ushort v139, v9, s[52:53] offset:2944
    global_load_dwordx4 v[44:47], v7, s[60:61] offset:0
    global_load_dwordx4 v[48:51], v7, s[60:61] offset:32
    global_load_dwordx4 v[52:55], v7, s[60:61] offset:64
    global_load_dwordx4 v[56:59], v7, s[60:61] offset:96
    global_load_dwordx4 v[60:63], v15, s[60:61] offset:0
    global_load_dwordx4 v[64:67], v15, s[60:61] offset:32
    global_load_dwordx4 v[68:71], v15, s[60:61] offset:64
    global_load_dwordx4 v[72:75], v15, s[60:61] offset:96
    global_load_dwordx4 v[76:79], v11, s[60:61] offset:0
    global_load_dwordx4 v[80:83], v11, s[60:61] offset:32
    global_load_dwordx4 v[84:87], v11, s[60:61] offset:64
    global_load_dwordx4 v[88:91], v11, s[60:61] offset:96
    s_lshl_b32 s63, s9, 12
    s_add_u32 s63, s63, 0x3b9000
    s_add_u32 s64, s4, s63
    s_addc_u32 s65, s5, 0
    s_mov_b32 s63, 0x80008000
    s_waitcnt vmcnt(12)
    v_lshl_or_b32 v92, v109, 16, v108
    v_lshl_or_b32 v93, v111, 16, v110
    v_lshl_or_b32 v94, v113, 16, v112
    v_lshl_or_b32 v95, v115, 16, v114
    v_lshl_or_b32 v96, v117, 16, v116
    v_lshl_or_b32 v97, v119, 16, v118
    v_lshl_or_b32 v98, v121, 16, v120
    v_lshl_or_b32 v99, v123, 16, v122
    v_lshl_or_b32 v100, v125, 16, v124
    v_lshl_or_b32 v101, v127, 16, v126
    v_lshl_or_b32 v102, v129, 16, v128
    v_lshl_or_b32 v103, v131, 16, v130
    v_lshl_or_b32 v104, v133, 16, v132
    v_lshl_or_b32 v105, v135, 16, v134
    v_lshl_or_b32 v106, v137, 16, v136
    v_lshl_or_b32 v107, v139, 16, v138
    s_waitcnt vmcnt(0)
    v_xor_b32 v76, s63, v76
    v_and_b32 v76, s62, v76
    v_xor_b32 v77, s63, v77
    v_and_b32 v77, s62, v77
    v_xor_b32 v78, s63, v78
    v_and_b32 v78, s62, v78
    v_xor_b32 v79, s63, v79
    v_and_b32 v79, s62, v79
    v_xor_b32 v80, s63, v80
    v_and_b32 v80, s62, v80
    v_xor_b32 v81, s63, v81
    v_and_b32 v81, s62, v81
    v_xor_b32 v82, s63, v82
    v_and_b32 v82, s62, v82
    v_xor_b32 v83, s63, v83
    v_and_b32 v83, s62, v83
    v_xor_b32 v84, s63, v84
    v_and_b32 v84, s62, v84
    v_xor_b32 v85, s63, v85
    v_and_b32 v85, s62, v85
    v_xor_b32 v86, s63, v86
    v_and_b32 v86, s62, v86
    v_xor_b32 v87, s63, v87
    v_and_b32 v87, s62, v87
    v_xor_b32 v88, s63, v88
    v_and_b32 v88, s62, v88
    v_xor_b32 v89, s63, v89
    v_and_b32 v89, s62, v89
    v_xor_b32 v90, s63, v90
    v_and_b32 v90, s62, v90
    v_xor_b32 v91, s63, v91
    v_and_b32 v91, s62, v91
    s_nop 1
    v_mfma_f32_32x32x16_bf16 v[108:123], v[76:79], v[92:95], 0
    v_mfma_f32_32x32x16_bf16 v[108:123], v[80:83], v[96:99], v[108:123]
    v_mfma_f32_32x32x16_bf16 v[108:123], v[84:87], v[100:103], v[108:123]
    v_mfma_f32_32x32x16_bf16 v[108:123], v[88:91], v[104:107], v[108:123]
    s_nop 9
    v_mfma_f32_32x32x16_bf16 v[124:139], v[60:63], v[92:95], v[108:123]
    v_mfma_f32_32x32x16_bf16 v[124:139], v[64:67], v[96:99], v[124:139]
    v_mfma_f32_32x32x16_bf16 v[124:139], v[68:71], v[100:103], v[124:139]
    v_mfma_f32_32x32x16_bf16 v[124:139], v[72:75], v[104:107], v[124:139]
    v_mfma_f32_32x32x16_bf16 v[108:123], v[44:47], v[92:95], v[108:123]
    v_mfma_f32_32x32x16_bf16 v[108:123], v[48:51], v[96:99], v[108:123]
    v_mfma_f32_32x32x16_bf16 v[108:123], v[52:55], v[100:103], v[108:123]
    v_mfma_f32_32x32x16_bf16 v[108:123], v[56:59], v[104:107], v[108:123]
    s_nop 11
    v_cvt_pk_bf16_f32 v44, v108, v109
    v_cvt_pk_bf16_f32 v45, v110, v111
    v_cvt_pk_bf16_f32 v46, v112, v113
    v_cvt_pk_bf16_f32 v47, v114, v115
    v_cvt_pk_bf16_f32 v48, v116, v117
    v_cvt_pk_bf16_f32 v49, v118, v119
    v_cvt_pk_bf16_f32 v50, v120, v121
    v_cvt_pk_bf16_f32 v51, v122, v123
    v_cvt_pk_bf16_f32 v52, v124, v125
    v_cvt_pk_bf16_f32 v53, v126, v127
    v_cvt_pk_bf16_f32 v54, v128, v129
    v_cvt_pk_bf16_f32 v55, v130, v131
    v_cvt_pk_bf16_f32 v56, v132, v133
    v_cvt_pk_bf16_f32 v57, v134, v135
    v_cvt_pk_bf16_f32 v58, v136, v137
    v_cvt_pk_bf16_f32 v59, v138, v139
    global_store_dwordx4 v1, v[44:47], s[64:65] offset:0 sc1
    global_store_dwordx4 v1, v[48:51], s[64:65] offset:1024 sc1
    global_store_dwordx4 v1, v[52:55], s[64:65] offset:2048 sc1
    global_store_dwordx4 v1, v[56:59], s[64:65] offset:3072 sc1
    s_mov_b64 exec, 1
    s_waitcnt vmcnt(0)
    global_store_dword v6, v13, s[56:57] sc1
    s_endpgm
KF_END:
    s_endpgm
.section .rodata,"a"
.p2align 6
.amdhsa_kernel gather_scatter__hybrid_graph_tf_graphgps__graph_kernel
  .amdhsa_next_free_vgpr 168
  .amdhsa_next_free_sgpr 102
  .amdhsa_accum_offset 168
  .amdhsa_group_segment_fixed_size 0
  .amdhsa_kernarg_size 96
  .amdhsa_user_sgpr_count 2
  .amdhsa_user_sgpr_kernarg_segment_ptr 1
  .amdhsa_system_sgpr_workgroup_id_x 1
  .amdhsa_float_denorm_mode_32 3
  .amdhsa_float_denorm_mode_16_64 3
.end_amdhsa_kernel
```
